```python
import torch

def _softmax(x, axis=-1):
    return torch.softmax(x, dim=axis)
def _gelu(x):
    return torch.nn.functional.gelu(x, approximate="tanh")
def _silu(x):
    return torch.nn.functional.silu(x)
def _sigmoid(x):
    return torch.sigmoid(x)
def _layernorm(x, axis=-1, eps=1e-5):
    m = x.mean(dim=axis, keepdim=True)
    v = x.var(dim=axis, keepdim=True, unbiased=False)
    return (x - m) / torch.sqrt(v + eps)
def _scatter_add(tgt, idx, src, axis=0):
    return tgt.clone().index_add_(axis, idx, src)
def _segment_sum(src, seg, n):
    out = torch.zeros((n,) + src.shape[1:], dtype=src.dtype)
    return out.index_add_(0, seg, src)
def _pad(x, pw):
    flat = tuple(v for pair in reversed(pw) for v in pair)
    return torch.nn.functional.pad(x, flat)

kernel_name = 'standalone__dense_activation_gelu__prompt'

def setup_inputs():

    _w = (lambda a: (lambda t: t.to(torch.bfloat16) if t.is_floating_point() else t)(torch.as_tensor(a)))
    B, S, D, F = 1, 2048, 512, 1376
    return {
        "x": _w((lambda *s: torch.randn(*s, dtype=torch.bfloat16) * 0.05)(B, S, D)),
        "w1": _w((lambda *s: torch.randn(*s, dtype=torch.bfloat16) * 3.2)(D, F) * (D ** -0.5)),
        "b1": _w((lambda *s: torch.randn(*s, dtype=torch.bfloat16) * 3.2)(F) * 0.01),
        "w2": _w((lambda *s: torch.randn(*s, dtype=torch.bfloat16) * 0.05)(F, D) * (F ** -0.5)),
        "b2": _w((lambda *s: torch.randn(*s, dtype=torch.bfloat16) * 0.1)(D) * 0.01),
    }

def reference(x, w1, b1, w2, b2):
    h = torch.einsum("bsd,df->bsf", x, w1) + b1
    h = _gelu(h)
    return torch.einsum("bsf,fd->bsd", h, w2) + b2
```

```asm
; @launch grid=(256,1,1) block=(512,1,1) lds=163840
.amdgcn_target "amdgcn-amd-amdhsa--gfx950"
.text
.globl standalone__dense_activation_gelu__prompt_kernel
.p2align 12
.p2align 8
.type standalone__dense_activation_gelu__prompt_kernel,@function
standalone__dense_activation_gelu__prompt_kernel:
    s_load_dwordx16 s[16:31], s[0:1], 0
    s_memrealtime s[70:71]
    s_cmp_ge_u32 s2, 256
    s_cbranch_scc1 L_end
    v_lshrrev_b32 v2, 6, v0
    v_and_b32 v1, 63, v0
    s_and_b32 s9, s2, 1
    v_readfirstlane_b32 s5, v2
    s_getpc_b64 s[40:41]
L_pc:
    s_lshr_b32 s7, s2, 3
    s_lshl_b32 s7, s7, 2
    s_cmp_ge_u32 s5, 4
    s_cbranch_scc1 L_nocpf
    s_add_u32 s7, s7, s5
    s_lshl_b32 s7, s7, 7
    s_min_u32 s7, s7, L_end-L_pc-64
    s_load_dword s44, s[40:41], s7
    s_load_dword s45, s[40:41], s7 offset:64
L_nocpf:
    s_bfe_u32 s4, s2, 0x30003
    s_lshr_b32 s7, s2, 6
    s_bfe_u32 s8, s2, 0x20001
    s_lshl_b32 s3, s8, 2
    s_add_u32 s3, s3, s7
    s_add_u32 s6, s7, s4
    s_mul_i32 s53, s9, 22
    s_mul_i32 s8, s4, 3
    s_add_u32 s53, s53, s8
    s_lshr_b32 s7, s7, 1
    s_xor_b32 s9, s9, s7
    s_xor_b32 s9, s9, 1
    s_cmp_eq_u32 s4, 7
    s_cselect_b32 s52, s9, 3
    s_cselect_b32 s53, 21, s53
    s_mov_b32 s54, s3
    s_bfe_u32 s55, s2, 0x20003
    s_and_b32 s8, s2, 1
    s_lshl_b32 s8, s8, 2
    s_or_b32 s55, s55, s8
    s_bfe_u32 s8, s2, 0x10005
    s_lshl_b32 s8, s8, 3
    s_or_b32 s55, s55, s8
    v_lshlrev_b32 v4, 4, v1
    v_mov_b32 v5, 0
    s_mov_b32 s9, s5
    s_and_b32 s5, s5, 3
    s_lshl_b32 s10, s5, 12
    s_cmp_lt_u32 s9, 4
    s_cbranch_scc1 L_compute
    s_setprio 1
    s_mul_i32 s11, s5, 3072
    s_cmp_eq_u32 s52, 0
    s_cselect_b32 s9, 0x40000000, 0
    s_lshl_b32 s8, s53, 6
    s_mul_i32 s7, s5, 44032
    s_add_u32 s8, s8, s7
    s_lshl_b32 s7, s52, 2
    v_mov_b32 v21, 0x40000000
    v_add_u32 v2, 0, v1
    v_mul_u32_u24 v3, 0x5556, v2
    v_lshrrev_b32 v3, 18, v3
    v_mul_u32_u24 v12, 2560, v3
    v_mul_u32_u24 v3, 12, v3
    v_sub_u32 v2, v2, v3
    v_cmp_gt_u32 vcc, s7, v2
    v_add3_u32 v12, v12, v4, s8
    s_nop 0
    v_cndmask_b32 v12, v21, v12, vcc
    v_add_u32 v2, 64, v1
    v_mul_u32_u24 v3, 0x5556, v2
    v_lshrrev_b32 v3, 18, v3
    v_mul_u32_u24 v13, 2560, v3
    v_mul_u32_u24 v3, 12, v3
    v_sub_u32 v2, v2, v3
    v_cmp_gt_u32 vcc, s7, v2
    v_add3_u32 v13, v13, v4, s8
    s_nop 0
    v_cndmask_b32 v13, v21, v13, vcc
    v_add_u32 v2, 128, v1
    v_mul_u32_u24 v3, 0x5556, v2
    v_lshrrev_b32 v3, 18, v3
    v_mul_u32_u24 v14, 2560, v3
    v_mul_u32_u24 v3, 12, v3
    v_sub_u32 v2, v2, v3
    v_cmp_gt_u32 vcc, s7, v2
    v_add3_u32 v14, v14, v4, s8
    s_nop 0
    v_cndmask_b32 v14, v21, v14, vcc
    s_lshl_b32 s8, s3, 17
    s_lshl_b32 s7, s5, 15
    s_add_u32 s8, s8, s7
    s_add_u32 s8, s8, s9
    v_lshrrev_b32 v2, 3, v1
    v_and_b32 v3, 7, v1
    v_lshrrev_b32 v8, 1, v2
    v_xor_b32 v8, v8, v3
    v_lshlrev_b32 v8, 4, v8
    v_lshl_add_u32 v8, v2, 10, v8
    v_add_u32 v8, s8, v8
    v_xor_b32 v9, 64, v8
    v_add_u32 v9, 7168, v9
    v_add_u32 v10, 14336, v8
    v_add_u32 v11, 14336, v9
    s_waitcnt lgkmcnt(0)
    s_mov_b32 s36, s18
    s_and_b32 s37, s19, 0xffff
    s_mov_b32 s38, 1409024
    s_mov_b32 s39, 0x20000
    s_mov_b32 s32, s16
    s_and_b32 s33, s17, 0xffff
    s_mov_b32 s34, 2097152
    s_mov_b32 s35, 0x20000
    s_add_u32 m0, s11, 0
    s_add_u32 s8, s6, 0
    s_and_b32 s8, s8, 3
    s_and_b32 s57, s4, 4
    s_or_b32 s8, s8, s57
    s_mul_i32 s13, s8, 176128
    s_lshl_b32 s12, s8, 7
    buffer_load_dwordx4 v12, s[36:39], s13 offen offset:0  lds
    buffer_load_dwordx4 v13, s[36:39], s13 offen offset:1024  lds
    buffer_load_dwordx4 v14, s[36:39], s13 offen offset:2048  lds
    s_add_u32 m0, s10, 98304
    s_nop 0
    buffer_load_dwordx4 v8, s[32:35], s12 offen offset:0  lds
    buffer_load_dwordx4 v9, s[32:35], s12 offen offset:1024  lds
    buffer_load_dwordx4 v10, s[32:35], s12 offen offset:2048  lds
    buffer_load_dwordx4 v11, s[32:35], s12 offen offset:3072  lds
    s_add_u32 m0, s11, 12288
    s_add_u32 s8, s6, 1
    s_and_b32 s8, s8, 3
    s_or_b32 s8, s8, s57
    s_mul_i32 s13, s8, 176128
    s_lshl_b32 s12, s8, 7
    buffer_load_dwordx4 v12, s[36:39], s13 offen offset:0  lds
    buffer_load_dwordx4 v13, s[36:39], s13 offen offset:1024  lds
    buffer_load_dwordx4 v14, s[36:39], s13 offen offset:2048  lds
    s_mov_b32 s40, s22
    s_and_b32 s41, s23, 0xffff
    s_mov_b32 s42, 1409024
    s_mov_b32 s43, 0x20000
    s_mov_b32 s48, s28
    s_and_b32 s49, s29, 0xffff
    s_mov_b32 s50, 256
    s_mov_b32 s51, 0x20000
    s_lshr_b32 s8, s2, 3
    s_and_b32 s9, s2, 1
    s_or_b32 s8, s8, s9
    s_or_b32 s8, s8, s5
    s_cselect_b32 s8, 0x7ffffff0, 0
    v_mov_b32 v2, s8
    s_or_b32 s8, s70, 1
    v_mov_b32 v20, s8
    s_lshr_b32 s9, s3, 2
    s_lshl_b32 s9, s9, 6
    s_mov_b64 exec, 1
    buffer_store_dword v20, v2, s[48:51], s9 offen sc0 sc1
    s_mov_b64 exec, -1
    s_add_u32 m0, s10, 114688
    s_nop 0
    buffer_load_dwordx4 v8, s[32:35], s12 offen offset:0  lds
    s_and_b32 s7, s54, 1
    s_lshl_b32 s7, s7, 1
    s_lshr_b32 s8, s55, 3
    s_add_u32 s9, s7, s8
    s_cmp_eq_u32 s9, 3
    s_cselect_b32 s9, 0, s9
    s_mul_i32 s8, s5, 3
    s_add_u32 s8, s8, s9
    s_lshl_b32 s59, s8, 15
    s_add_u32 s60, s59, 393216
    s_sub_u32 s8, s60, 1409024
    s_cselect_b32 s60, s60, s8
    s_add_u32 s61, s60, 393216
    s_sub_u32 s8, s61, 1409024
    s_cselect_b32 s61, s61, s8
    s_add_u32 s62, s61, 393216
    s_sub_u32 s8, s62, 1409024
    s_cselect_b32 s62, s62, s8
    s_add_u32 s63, s62, 393216
    s_sub_u32 s8, s63, 1409024
    s_cselect_b32 s63, s63, s8
    s_add_u32 s64, s63, 393216
    s_sub_u32 s8, s64, 1409024
    s_cselect_b32 s64, s64, s8
    s_add_u32 s65, s64, 393216
    s_sub_u32 s8, s65, 1409024
    s_cselect_b32 s65, s65, s8
    s_add_u32 s66, s65, 393216
    s_sub_u32 s8, s66, 1409024
    s_cselect_b32 s66, s66, s8
    s_add_u32 s67, s66, 393216
    s_sub_u32 s8, s67, 1409024
    s_cselect_b32 s67, s67, s8
    s_add_u32 s68, s67, 393216
    s_sub_u32 s8, s68, 1409024
    s_cselect_b32 s68, s68, s8
    s_add_u32 s69, s68, 393216
    s_sub_u32 s8, s69, 1409024
    s_cselect_b32 s69, s69, s8
    buffer_load_dwordx4 v9, s[32:35], s12 offen offset:1024  lds
    v_lshrrev_b32 v2, 3, v1
    v_and_b32 v3, 7, v1
    v_lshlrev_b32 v16, 1, v2
    v_and_b32 v16, 4, v16
    v_xor_b32 v16, v16, v3
    v_lshlrev_b32 v16, 4, v16
    v_lshl_add_u32 v16, v2, 10, v16
    s_and_b32 s8, s55, 7
    s_lshl_b32 s8, s8, 7
    v_add_u32 v16, s8, v16
    v_add_u32 v17, 7168, v16
    v_add_u32 v18, 14336, v16
    v_add_u32 v19, 21504, v16
    s_setprio 0
    buffer_load_dwordx4 v10, s[32:35], s12 offen offset:2048  lds
    s_lshr_b32 s7, s2, 3
    s_mul_i32 s8, s7, 44
    s_mul_i32 s9, s5, 11
    s_add_u32 s8, s8, s9
    s_lshl_b32 s8, s8, 10
    s_and_b32 s9, s2, 1
    s_lshl_b32 s9, s9, 9
    s_add_u32 s8, s8, s9
    v_and_b32 v2, 512, v4
    v_add3_u32 v21, s8, v4, v2
    s_lshr_b32 s7, s7, 0
    s_and_b32 s15, s7, 1
    buffer_load_dwordx4 v11, s[32:35], s12 offen offset:3072  lds
    s_cmp_lg_u32 s15, 0
    s_cbranch_scc1 L_nt0
    buffer_load_dwordx4 v[32:35], v21, s[40:43], 0 offen offset:0
    buffer_load_dwordx4 v[40:43], v21, s[40:43], 0 offen offset:2048
    s_movk_i32 s7, 4096
    buffer_load_dwordx4 v[48:51], v21, s[40:43], s7 offen offset:0
    buffer_load_dwordx4 v[56:59], v21, s[40:43], s7 offen offset:2048
    s_movk_i32 s7, 8192
    buffer_load_dwordx4 v[64:67], v21, s[40:43], s7 offen offset:0
    buffer_load_dwordx4 v[72:75], v21, s[40:43], s7 offen offset:2048
L_nt0:
    s_add_u32 m0, s11, 24576
    s_add_u32 s8, s6, 2
    s_and_b32 s8, s8, 3
    s_or_b32 s8, s8, s57
    s_mul_i32 s13, s8, 176128
    s_lshl_b32 s12, s8, 7
    buffer_load_dwordx4 v12, s[36:39], s13 offen offset:0  lds
    s_waitcnt vmcnt(9)
    s_barrier
    buffer_load_dwordx4 v13, s[36:39], s13 offen offset:1024  lds
    buffer_load_dwordx4 v14, s[36:39], s13 offen offset:2048  lds
    s_add_u32 m0, s10, 131072
    s_nop 0
    buffer_load_dwordx4 v8, s[32:35], s12 offen offset:0  lds
    buffer_load_dwordx4 v9, s[32:35], s12 offen offset:1024  lds
    buffer_load_dwordx4 v10, s[32:35], s12 offen offset:2048  lds
    buffer_load_dwordx4 v11, s[32:35], s12 offen offset:3072  lds
    s_add_u32 m0, s11, 36864
    s_add_u32 s8, s6, 3
    s_and_b32 s8, s8, 3
    s_or_b32 s8, s8, s57
    s_mul_i32 s13, s8, 176128
    s_lshl_b32 s12, s8, 7
    buffer_load_dwordx4 v12, s[36:39], s13 offen offset:0  lds
    s_waitcnt vmcnt(8)
    s_barrier
    buffer_load_dwordx4 v13, s[36:39], s13 offen offset:1024  lds
    buffer_load_dwordx4 v14, s[36:39], s13 offen offset:2048  lds
    s_add_u32 m0, s10, 147456
    s_nop 0
    buffer_load_dwordx4 v8, s[32:35], s12 offen offset:0  lds
    buffer_load_dwordx4 v9, s[32:35], s12 offen offset:1024  lds
    buffer_load_dwordx4 v10, s[32:35], s12 offen offset:2048  lds
    buffer_load_dwordx4 v11, s[32:35], s12 offen offset:3072  lds
    s_add_u32 m0, s11, 49152
    s_add_u32 s8, s6, 4
    s_and_b32 s8, s8, 3
    s_xor_b32 s57, s57, 4
    s_or_b32 s8, s8, s57
    s_mul_i32 s13, s8, 176128
    s_lshl_b32 s12, s8, 7
    buffer_load_dwordx4 v12, s[36:39], s13 offen offset:0  lds
    s_waitcnt vmcnt(8)
    s_barrier
    buffer_load_dwordx4 v13, s[36:39], s13 offen offset:1024  lds
    buffer_load_dwordx4 v14, s[36:39], s13 offen offset:2048  lds
    s_cmp_lg_u32 s15, 1
    s_cbranch_scc1 L_nt1
    buffer_load_dwordx4 v[32:35], v21, s[40:43], 0 offen offset:0
    buffer_load_dwordx4 v[40:43], v21, s[40:43], 0 offen offset:2048
    s_movk_i32 s7, 4096
    buffer_load_dwordx4 v[48:51], v21, s[40:43], s7 offen offset:0
    buffer_load_dwordx4 v[56:59], v21, s[40:43], s7 offen offset:2048
    s_movk_i32 s7, 8192
    buffer_load_dwordx4 v[64:67], v21, s[40:43], s7 offen offset:0
    buffer_load_dwordx4 v[72:75], v21, s[40:43], s7 offen offset:2048
L_nt1:
    s_add_u32 m0, s10, 98304
    s_nop 0
    buffer_load_dwordx4 v8, s[32:35], s12 offen offset:0  lds
    buffer_load_dwordx4 v9, s[32:35], s12 offen offset:1024  lds
    buffer_load_dwordx4 v10, s[32:35], s12 offen offset:2048  lds
    buffer_load_dwordx4 v11, s[32:35], s12 offen offset:3072  lds
    s_add_u32 m0, s11, 61440
    s_add_u32 s8, s6, 5
    s_and_b32 s8, s8, 3
    s_or_b32 s8, s8, s57
    s_mul_i32 s13, s8, 176128
    s_lshl_b32 s12, s8, 7
    buffer_load_dwordx4 v12, s[36:39], s13 offen offset:0  lds
    s_waitcnt vmcnt(8)
    s_barrier
    buffer_load_dwordx4 v13, s[36:39], s13 offen offset:1024  lds
    buffer_load_dwordx4 v14, s[36:39], s13 offen offset:2048  lds
    s_add_u32 m0, s10, 114688
    s_nop 0
    buffer_load_dwordx4 v8, s[32:35], s12 offen offset:0  lds
    buffer_load_dwordx4 v9, s[32:35], s12 offen offset:1024  lds
    buffer_load_dwordx4 v10, s[32:35], s12 offen offset:2048  lds
    buffer_load_dwordx4 v11, s[32:35], s12 offen offset:3072  lds
    s_add_u32 m0, s11, 73728
    s_add_u32 s8, s6, 6
    s_and_b32 s8, s8, 3
    s_or_b32 s8, s8, s57
    s_mul_i32 s13, s8, 176128
    s_lshl_b32 s12, s8, 7
    buffer_load_dwordx4 v12, s[36:39], s13 offen offset:0  lds
    s_waitcnt vmcnt(8)
    s_barrier
    buffer_load_dwordx4 v13, s[36:39], s13 offen offset:1024  lds
    buffer_load_dwordx4 v14, s[36:39], s13 offen offset:2048  lds
    s_add_u32 m0, s10, 131072
    s_nop 0
    buffer_load_dwordx4 v8, s[32:35], s12 offen offset:0  lds
    buffer_load_dwordx4 v9, s[32:35], s12 offen offset:1024  lds
    buffer_load_dwordx4 v10, s[32:35], s12 offen offset:2048  lds
    buffer_load_dwordx4 v11, s[32:35], s12 offen offset:3072  lds
    s_add_u32 m0, s11, 86016
    s_add_u32 s8, s6, 7
    s_and_b32 s8, s8, 3
    s_or_b32 s8, s8, s57
    s_mul_i32 s13, s8, 176128
    s_lshl_b32 s12, s8, 7
    buffer_load_dwordx4 v12, s[36:39], s13 offen offset:0  lds
    s_waitcnt vmcnt(8)
    s_barrier
    buffer_load_dwordx4 v13, s[36:39], s13 offen offset:1024  lds
    buffer_load_dwordx4 v14, s[36:39], s13 offen offset:2048  lds
    s_add_u32 m0, s10, 147456
    s_nop 0
    buffer_load_dwordx4 v8, s[32:35], s12 offen offset:0  lds
    buffer_load_dwordx4 v9, s[32:35], s12 offen offset:1024  lds
    buffer_load_dwordx4 v10, s[32:35], s12 offen offset:2048  lds
    buffer_load_dwordx4 v11, s[32:35], s12 offen offset:3072  lds
    s_add_u32 m0, s10, 0
    s_nop 0
    buffer_load_dwordx4 v16, s[40:43], s59 offen offset:0  lds
    s_waitcnt vmcnt(8)
    s_barrier
    buffer_load_dwordx4 v17, s[40:43], s59 offen offset:1024  lds
    buffer_load_dwordx4 v18, s[40:43], s59 offen offset:2048  lds
    buffer_load_dwordx4 v19, s[40:43], s59 offen offset:3072  lds
    s_add_u32 m0, s10, 16384
    s_nop 0
    buffer_load_dwordx4 v16, s[40:43], s60 offen offset:0  lds
    buffer_load_dwordx4 v17, s[40:43], s60 offen offset:1024  lds
    buffer_load_dwordx4 v18, s[40:43], s60 offen offset:2048  lds
    buffer_load_dwordx4 v19, s[40:43], s60 offen offset:3072  lds
    s_waitcnt vmcnt(8)
    s_barrier
    s_add_u32 m0, s10, 32768
    s_nop 0
    buffer_load_dwordx4 v16, s[40:43], s61 offen offset:0  lds
    buffer_load_dwordx4 v17, s[40:43], s61 offen offset:1024  lds
    buffer_load_dwordx4 v18, s[40:43], s61 offen offset:2048  lds
    buffer_load_dwordx4 v19, s[40:43], s61 offen offset:3072  lds
    s_add_u32 m0, s10, 98304
    s_nop 0
    buffer_load_dwordx4 v16, s[40:43], s63 offen offset:0  lds
    buffer_load_dwordx4 v17, s[40:43], s63 offen offset:1024  lds
    buffer_load_dwordx4 v18, s[40:43], s63 offen offset:2048  lds
    buffer_load_dwordx4 v19, s[40:43], s63 offen offset:3072  lds
    s_barrier
    s_add_u32 m0, s10, 49152
    s_nop 0
    buffer_load_dwordx4 v16, s[40:43], s62 offen offset:0  lds
    buffer_load_dwordx4 v17, s[40:43], s62 offen offset:1024  lds
    buffer_load_dwordx4 v18, s[40:43], s62 offen offset:2048  lds
    buffer_load_dwordx4 v19, s[40:43], s62 offen offset:3072  lds
    s_waitcnt vmcnt(0)
    s_barrier
    s_add_u32 m0, s10, 114688
    s_nop 0
    buffer_load_dwordx4 v16, s[40:43], s64 offen offset:0  lds
    buffer_load_dwordx4 v17, s[40:43], s64 offen offset:1024  lds
    buffer_load_dwordx4 v18, s[40:43], s64 offen offset:2048  lds
    buffer_load_dwordx4 v19, s[40:43], s64 offen offset:3072  lds
    s_add_u32 m0, s10, 131072
    s_nop 0
    buffer_load_dwordx4 v16, s[40:43], s65 offen offset:0  lds
    buffer_load_dwordx4 v17, s[40:43], s65 offen offset:1024  lds
    buffer_load_dwordx4 v18, s[40:43], s65 offen offset:2048  lds
    buffer_load_dwordx4 v19, s[40:43], s65 offen offset:3072  lds
    s_add_u32 m0, s10, 147456
    s_nop 0
    buffer_load_dwordx4 v16, s[40:43], s66 offen offset:0  lds
    buffer_load_dwordx4 v17, s[40:43], s66 offen offset:1024  lds
    buffer_load_dwordx4 v18, s[40:43], s66 offen offset:2048  lds
    buffer_load_dwordx4 v19, s[40:43], s66 offen offset:3072  lds
    s_add_u32 m0, s10, 65536
    s_nop 0
    buffer_load_dwordx4 v16, s[40:43], s67 offen offset:0  lds
    buffer_load_dwordx4 v17, s[40:43], s67 offen offset:1024  lds
    buffer_load_dwordx4 v18, s[40:43], s67 offen offset:2048  lds
    buffer_load_dwordx4 v19, s[40:43], s67 offen offset:3072  lds
    s_add_u32 m0, s10, 81920
    s_nop 0
    buffer_load_dwordx4 v16, s[40:43], s68 offen offset:0  lds
    buffer_load_dwordx4 v17, s[40:43], s68 offen offset:1024  lds
    buffer_load_dwordx4 v18, s[40:43], s68 offen offset:2048  lds
    buffer_load_dwordx4 v19, s[40:43], s68 offen offset:3072  lds
    s_cmp_eq_u32 s5, 3
    s_cselect_b32 s8, 0x40000000, 0
    v_add_u32 v16, s8, v16
    v_add_u32 v17, s8, v17
    v_add_u32 v18, s8, v18
    v_add_u32 v19, s8, v19
    s_waitcnt vmcnt(12)
    s_barrier
    s_add_u32 m0, s10, 0
    s_nop 0
    buffer_load_dwordx4 v16, s[40:43], s69 offen offset:0  lds
    buffer_load_dwordx4 v17, s[40:43], s69 offen offset:1024  lds
    buffer_load_dwordx4 v18, s[40:43], s69 offen offset:2048  lds
    buffer_load_dwordx4 v19, s[40:43], s69 offen offset:3072  lds
    s_waitcnt vmcnt(4)
    s_barrier
    s_waitcnt vmcnt(0)
    s_barrier
    s_endpgm
L_compute:
    s_and_b32 s7, s3, 1
    s_lshl_b32 s7, s7, 1
    s_lshr_b32 s8, s5, 1
    s_add_u32 s7, s7, s8
    s_cmp_eq_u32 s7, 3
    s_cselect_b32 s13, 0, s7
    s_add_u32 s7, s13, 45
    s_sub_u32 s7, s7, s53
    s_mul_i32 s8, s7, 43
    s_lshr_b32 s8, s8, 7
    s_mul_i32 s8, s8, 3
    s_sub_u32 s56, s7, s8
    s_sub_u32 s57, s56, 1
    s_cselect_b32 s57, 2, s57
    s_sub_u32 s58, s57, 1
    s_cselect_b32 s58, 2, s58
    v_and_b32 v2, 31, v1
    v_lshrrev_b32 v3, 5, v1
    v_lshrrev_b32 v8, 1, v2
    v_and_b32 v8, 7, v8
    v_xor_b32 v8, v8, v3
    v_lshlrev_b32 v8, 4, v8
    v_lshl_add_u32 v8, v2, 7, v8
    s_add_u32 s8, s10, 98304
    v_add_u32 v8, s8, v8
    v_xor_b32 v9, 32, v8
    v_xor_b32 v10, 64, v8
    v_xor_b32 v11, 96, v8
    v_lshrrev_b32 v22, 2, v1
    v_lshlrev_b32 v22, 10, v22
    v_and_b32 v20, 3, v1
    v_lshl_add_u32 v22, v20, 4, v22
    v_bfe_u32 v2, v1, 4, 1
    v_lshlrev_b32 v2, 5, v2
    v_and_b32 v20, 3, v1
    v_lshl_add_u32 v2, v20, 3, v2
    v_bfe_u32 v20, v1, 2, 2
    v_lshl_add_u32 v12, v3, 3, v20
    v_mul_u32_u24 v12, 192, v12
    v_add_u32 v12, v12, v2
    s_lshl_b32 s8, s58, 6
    v_add_u32 v14, s8, v12
    s_lshl_b32 s8, s57, 6
    v_add_u32 v13, s8, v12
    s_lshl_b32 s8, s56, 6
    v_add_u32 v12, s8, v12
    v_lshl_add_u32 v6, v3, 2, v20
    v_lshl_add_u32 v6, v6, 7, v2
    v_lshrrev_b32 v20, 1, v20
    s_lshr_b32 s8, s5, 1
    v_xor_b32 v20, s8, v20
    v_lshl_add_u32 v6, v20, 6, v6
    s_lshl_b32 s8, s8, 12
    v_add_u32 v6, s8, v6
    v_xor_b32 v7, 64, v6
    v_cmp_gt_u32 vcc, 32, v1
    v_mov_b32 v2, 0x3f80
    v_lshlrev_b32 v3, 1, v1
    v_cndmask_b32 v160, 0, v2, vcc
    v_mov_b32 v2, 0x7ffffff0
    v_cndmask_b32 v23, v2, v3, vcc
    s_add_u32 s8, s53, s56
    s_lshl_b32 s8, s8, 6
    v_add_u32 v144, s8, v23
    s_add_u32 s8, s53, s57
    s_lshl_b32 s8, s8, 6
    v_add_u32 v148, s8, v23
    s_add_u32 s8, s53, s58
    s_lshl_b32 s8, s8, 6
    v_add_u32 v152, s8, v23
    s_and_b32 s8, s55, 7
    s_lshl_b32 s8, s8, 7
    s_lshr_b32 s9, s5, 1
    s_lshl_b32 s9, s9, 6
    s_add_u32 s15, s8, s9
    v_add_u32 v156, s15, v23
    s_waitcnt lgkmcnt(0)
    s_mov_b32 s44, s20
    s_and_b32 s45, s21, 0xffff
    s_mov_b32 s46, 2752
    s_mov_b32 s47, 0x20000
    s_mov_b32 s48, s24
    s_and_b32 s49, s25, 0xffff
    s_mov_b32 s50, 1024
    s_mov_b32 s51, 0x20000
    buffer_load_ushort v144, v144, s[44:47], 0 offen
    buffer_load_ushort v148, v148, s[44:47], 0 offen
    buffer_load_ushort v152, v152, s[44:47], 0 offen
    buffer_load_ushort v156, v156, s[48:51], 0 offen
    s_mov_b32 s32, s30
    s_and_b32 s33, s31, 0xffff
    s_mov_b32 s34, 7340032
    s_mov_b32 s35, 0x20000
    s_mov_b32 s36, s26
    s_and_b32 s37, s27, 0xffff
    s_mov_b32 s38, 2097152
    s_mov_b32 s39, 0x20000
    s_mov_b64 s[0:1], s[28:29]
    s_mov_b32 s31, s13
    s_lshl_b32 s7, s54, 1
    s_lshr_b32 s8, s55, 3
    s_add_u32 s7, s7, s8
    s_lshl_b32 s7, s7, 10
    s_lshl_b32 s8, s5, 8
    s_add_u32 s7, s7, s8
    s_add_u32 s30, s7, 6291456
    s_buffer_load_dword s16, s[32:35], s30 offset:0 glc
    s_buffer_load_dword s17, s[32:35], s30 offset:64 glc
    s_buffer_load_dword s18, s[32:35], s30 offset:128 glc
    s_barrier
    ds_read_b128 v[80:83], v8 offset:0
    ds_read_b64_tr_b16 v[84:85], v12 offset:0
    ds_read_b64_tr_b16 v[86:87], v12 offset:768
    ds_read_b64_tr_b16 v[88:89], v13 offset:0
    ds_read_b64_tr_b16 v[90:91], v13 offset:768
    ds_read_b64_tr_b16 v[92:93], v14 offset:0
    ds_read_b64_tr_b16 v[94:95], v14 offset:768
    ds_read_b128 v[96:99], v9 offset:0
    ds_read_b64_tr_b16 v[100:101], v12 offset:3072
    ds_read_b64_tr_b16 v[102:103], v12 offset:3840
    ds_read_b64_tr_b16 v[104:105], v13 offset:3072
    ds_read_b64_tr_b16 v[106:107], v13 offset:3840
    ds_read_b64_tr_b16 v[108:109], v14 offset:3072
    ds_read_b64_tr_b16 v[110:111], v14 offset:3840
    s_waitcnt lgkmcnt(11)
    v_mfma_f32_32x32x16_bf16 v[32:47], v[84:87], v[80:83], 0
    ds_read_b128 v[112:115], v10 offset:0
    ds_read_b64_tr_b16 v[116:117], v12 offset:6144
    ds_read_b64_tr_b16 v[118:119], v12 offset:6912
    v_mov_b32 v145, 0
    s_waitcnt lgkmcnt(12)
    v_mfma_f32_32x32x16_bf16 v[48:63], v[88:91], v[80:83], 0
    ds_read_b64_tr_b16 v[120:121], v13 offset:6144
    ds_read_b64_tr_b16 v[122:123], v13 offset:6912
    v_mov_b32 v146, 0
    v_mov_b32 v147, 0
    s_waitcnt lgkmcnt(12)
    v_mfma_f32_32x32x16_bf16 v[64:79], v[92:95], v[80:83], 0
    ds_read_b64_tr_b16 v[124:125], v14 offset:6144
    ds_read_b64_tr_b16 v[126:127], v14 offset:6912
    v_mov_b32 v149, 0
    v_mov_b32 v150, 0
    s_waitcnt lgkmcnt(11)
    v_mfma_f32_32x32x16_bf16 v[32:47], v[100:103], v[96:99], v[32:47]
    ds_read_b128 v[80:83], v11 offset:0
    ds_read_b64_tr_b16 v[84:85], v12 offset:9216
    ds_read_b64_tr_b16 v[86:87], v12 offset:9984
    v_mov_b32 v151, 0
    s_waitcnt lgkmcnt(12)
    v_mfma_f32_32x32x16_bf16 v[48:63], v[104:107], v[96:99], v[48:63]
    ds_read_b64_tr_b16 v[88:89], v13 offset:9216
    ds_read_b64_tr_b16 v[90:91], v13 offset:9984
    v_mov_b32 v153, 0
    v_mov_b32 v154, 0
    s_waitcnt lgkmcnt(12)
    v_mfma_f32_32x32x16_bf16 v[64:79], v[108:111], v[96:99], v[64:79]
    ds_read_b64_tr_b16 v[92:93], v14 offset:9216
    ds_read_b64_tr_b16 v[94:95], v14 offset:9984
    v_mov_b32 v155, 0
    v_mov_b32 v157, 0
    v_mov_b32 v158, 0
    v_mov_b32 v159, 0
    v_mov_b32 v161, 0
    v_mov_b32 v162, 0
    v_mov_b32 v163, 0
    s_lshl_b32 s7, s3, 2
    s_add_u32 s7, s7, s5
    s_mul_i32 s7, s7, 98304
    s_lshl_b32 s8, s53, 11
    s_add_u32 s7, s7, s8
    s_lshl_b32 s8, s56, 11
    s_add_u32 s26, s8, s7
    s_lshl_b32 s8, s57, 11
    s_add_u32 s27, s8, s7
    s_lshl_b32 s8, s58, 11
    s_add_u32 s28, s8, s7
    s_barrier
    s_waitcnt lgkmcnt(11)
    v_mfma_f32_32x32x16_bf16 v[32:47], v[116:119], v[112:115], v[32:47]
    ds_read_b128 v[96:99], v8 offset:16384
    ds_read_b64_tr_b16 v[100:101], v12 offset:12288
    ds_read_b64_tr_b16 v[102:103], v12 offset:13056
    s_and_b32 s7, s54, 1
    s_waitcnt lgkmcnt(12)
    v_mfma_f32_32x32x16_bf16 v[48:63], v[120:123], v[112:115], v[48:63]
    ds_read_b64_tr_b16 v[104:105], v13 offset:12288
    ds_read_b64_tr_b16 v[106:107], v13 offset:13056
    s_lshl_b32 s7, s7, 1
    s_lshr_b32 s8, s55, 3
    s_waitcnt lgkmcnt(12)
    v_mfma_f32_32x32x16_bf16 v[64:79], v[124:127], v[112:115], v[64:79]
    ds_read_b64_tr_b16 v[108:109], v14 offset:12288
    ds_read_b64_tr_b16 v[110:111], v14 offset:13056
    s_add_u32 s9, s7, s8
    s_cmp_eq_u32 s9, 3
    s_waitcnt lgkmcnt(11)
    v_mfma_f32_32x32x16_bf16 v[32:47], v[84:87], v[80:83], v[32:47]
    ds_read_b128 v[112:115], v9 offset:16384
    ds_read_b64_tr_b16 v[116:117], v12 offset:15360
    ds_read_b64_tr_b16 v[118:119], v12 offset:16128
    s_cselect_b32 s9, 0, s9
    s_waitcnt lgkmcnt(12)
    v_mfma_f32_32x32x16_bf16 v[48:63], v[88:91], v[80:83], v[48:63]
    ds_read_b64_tr_b16 v[120:121], v13 offset:15360
    ds_read_b64_tr_b16 v[122:123], v13 offset:16128
    s_lshr_b32 s8, s5, 1
    s_mul_i32 s8, s8, 3
    s_waitcnt lgkmcnt(12)
    v_mfma_f32_32x32x16_bf16 v[64:79], v[92:95], v[80:83], v[64:79]
    ds_read_b64_tr_b16 v[124:125], v14 offset:15360
    ds_read_b64_tr_b16 v[126:127], v14 offset:16128
    s_add_u32 s8, s8, s9
    s_lshl_b32 s59, s8, 11
    s_waitcnt lgkmcnt(11)
    v_mfma_f32_32x32x16_bf16 v[32:47], v[100:103], v[96:99], v[32:47]
    ds_read_b128 v[80:83], v10 offset:16384
    ds_read_b64_tr_b16 v[84:85], v12 offset:18432
    ds_read_b64_tr_b16 v[86:87], v12 offset:19200
    s_lshr_b32 s11, s3, 2
    s_waitcnt lgkmcnt(12)
    v_mfma_f32_32x32x16_bf16 v[48:63], v[104:107], v[96:99], v[48:63]
    ds_read_b64_tr_b16 v[88:89], v13 offset:18432
    ds_read_b64_tr_b16 v[90:91], v13 offset:19200
    s_lshl_b32 s11, s11, 6
    s_lshl_b32 s7, s3, 1
    s_waitcnt lgkmcnt(12)
    v_mfma_f32_32x32x16_bf16 v[64:79], v[108:111], v[96:99], v[64:79]
    ds_read_b64_tr_b16 v[92:93], v14 offset:18432
    ds_read_b64_tr_b16 v[94:95], v14 offset:19200
    s_lshr_b32 s8, s5, 1
    s_add_u32 s7, s7, s8
    s_waitcnt lgkmcnt(11)
    v_mfma_f32_32x32x16_bf16 v[32:47], v[116:119], v[112:115], v[32:47]
    ds_read_b128 v[96:99], v11 offset:16384
    ds_read_b64_tr_b16 v[100:101], v12 offset:21504
    ds_read_b64_tr_b16 v[102:103], v12 offset:22272
    s_lshl_b32 s7, s7, 10
    s_waitcnt lgkmcnt(12)
    v_mfma_f32_32x32x16_bf16 v[48:63], v[120:123], v[112:115], v[48:63]
    ds_read_b64_tr_b16 v[104:105], v13 offset:21504
    ds_read_b64_tr_b16 v[106:107], v13 offset:22272
    s_and_b32 s8, s5, 1
    s_lshl_b32 s8, s8, 8
    s_waitcnt lgkmcnt(12)
    v_mfma_f32_32x32x16_bf16 v[64:79], v[124:127], v[112:115], v[64:79]
    ds_read_b64_tr_b16 v[108:109], v14 offset:21504
    ds_read_b64_tr_b16 v[110:111], v14 offset:22272
    s_add_u32 s7, s7, s8
    s_add_u32 s7, s7, 6291456
    s_sub_u32 s13, s53, s31
    s_add_u32 s13, s13, 43
    s_add_u32 s8, s13, s56
    s_mul_i32 s8, s8, 29
    s_mul_hi_u32 s9, s8, 99882961
    s_mul_i32 s9, s9, 43
    s_sub_u32 s8, s8, s9
    s_cmp_lt_u32 s56, s52
    s_cselect_b32 s8, s8, 64
    s_and_b32 s9, s8, 1
    s_lshl_b32 s9, s9, 9
    s_add_u32 s24, s9, s7
    s_and_b32 s9, s8, 0x7e
    s_lshl_b32 s9, s9, 1
    s_add_u32 s24, s24, s9
    s_cmp_ge_u32 s8, 14
    s_barrier
    s_waitcnt lgkmcnt(11)
    v_mfma_f32_32x32x16_bf16 v[32:47], v[84:87], v[80:83], v[32:47]
    ds_read_b128 v[112:115], v8 offset:32768
    ds_read_b64_tr_b16 v[116:117], v12 offset:24576
    ds_read_b64_tr_b16 v[118:119], v12 offset:25344
    s_cselect_b32 s9, 36, 0
    s_waitcnt lgkmcnt(12)
    v_mfma_f32_32x32x16_bf16 v[48:63], v[88:91], v[80:83], v[48:63]
    ds_read_b64_tr_b16 v[120:121], v13 offset:24576
    ds_read_b64_tr_b16 v[122:123], v13 offset:25344
    s_add_u32 s24, s24, s9
    s_cmp_ge_u32 s8, 28
    s_waitcnt lgkmcnt(12)
    v_mfma_f32_32x32x16_bf16 v[64:79], v[92:95], v[80:83], v[64:79]
    ds_read_b64_tr_b16 v[124:125], v14 offset:24576
    ds_read_b64_tr_b16 v[126:127], v14 offset:25344
    s_cselect_b32 s9, 36, 0
    s_add_u32 s24, s24, s9
    s_waitcnt lgkmcnt(11)
    v_mfma_f32_32x32x16_bf16 v[32:47], v[100:103], v[96:99], v[32:47]
    ds_read_b128 v[80:83], v9 offset:32768
    ds_read_b64_tr_b16 v[84:85], v12 offset:27648
    ds_read_b64_tr_b16 v[86:87], v12 offset:28416
    s_add_u32 s8, s13, s57
    s_waitcnt lgkmcnt(12)
    v_mfma_f32_32x32x16_bf16 v[48:63], v[104:107], v[96:99], v[48:63]
    ds_read_b64_tr_b16 v[88:89], v13 offset:27648
    ds_read_b64_tr_b16 v[90:91], v13 offset:28416
    s_mul_i32 s8, s8, 29
    s_mul_hi_u32 s9, s8, 99882961
    s_waitcnt lgkmcnt(12)
    v_mfma_f32_32x32x16_bf16 v[64:79], v[108:111], v[96:99], v[64:79]
    ds_read_b64_tr_b16 v[92:93], v14 offset:27648
    ds_read_b64_tr_b16 v[94:95], v14 offset:28416
    s_mul_i32 s9, s9, 43
    s_sub_u32 s8, s8, s9
    s_waitcnt lgkmcnt(11)
    v_mfma_f32_32x32x16_bf16 v[32:47], v[116:119], v[112:115], v[32:47]
    ds_read_b128 v[96:99], v10 offset:32768
    ds_read_b64_tr_b16 v[100:101], v12 offset:30720
    ds_read_b64_tr_b16 v[102:103], v12 offset:31488
    s_cmp_lt_u32 s57, s52
    s_waitcnt lgkmcnt(12)
    v_mfma_f32_32x32x16_bf16 v[48:63], v[120:123], v[112:115], v[48:63]
    ds_read_b64_tr_b16 v[104:105], v13 offset:30720
    ds_read_b64_tr_b16 v[106:107], v13 offset:31488
    s_cselect_b32 s8, s8, 64
    s_and_b32 s9, s8, 1
    s_waitcnt lgkmcnt(12)
    v_mfma_f32_32x32x16_bf16 v[64:79], v[124:127], v[112:115], v[64:79]
    ds_read_b64_tr_b16 v[108:109], v14 offset:30720
    ds_read_b64_tr_b16 v[110:111], v14 offset:31488
    s_lshl_b32 s9, s9, 9
    s_add_u32 s25, s9, s7
    s_waitcnt lgkmcnt(11)
    v_mfma_f32_32x32x16_bf16 v[32:47], v[84:87], v[80:83], v[32:47]
    ds_read_b128 v[112:115], v11 offset:32768
    ds_read_b64_tr_b16 v[116:117], v12 offset:33792
    ds_read_b64_tr_b16 v[118:119], v12 offset:34560
    s_and_b32 s9, s8, 0x7e
    s_waitcnt lgkmcnt(12)
    v_mfma_f32_32x32x16_bf16 v[48:63], v[88:91], v[80:83], v[48:63]
    ds_read_b64_tr_b16 v[120:121], v13 offset:33792
    ds_read_b64_tr_b16 v[122:123], v13 offset:34560
    s_lshl_b32 s9, s9, 1
    s_add_u32 s25, s25, s9
    s_waitcnt lgkmcnt(12)
    v_mfma_f32_32x32x16_bf16 v[64:79], v[92:95], v[80:83], v[64:79]
    ds_read_b64_tr_b16 v[124:125], v14 offset:33792
    ds_read_b64_tr_b16 v[126:127], v14 offset:34560
    s_cmp_ge_u32 s8, 14
    s_cselect_b32 s9, 36, 0
    s_add_u32 s25, s25, s9
    s_cmp_ge_u32 s8, 28
    s_cselect_b32 s9, 36, 0
    s_add_u32 s25, s25, s9
    s_add_u32 s8, s13, s58
    s_mul_i32 s8, s8, 29
    s_mul_hi_u32 s9, s8, 99882961
    s_mul_i32 s9, s9, 43
    s_sub_u32 s8, s8, s9
    s_cmp_lt_u32 s58, s52
    s_cselect_b32 s8, s8, 64
    s_and_b32 s9, s8, 1
    s_lshl_b32 s9, s9, 9
    s_add_u32 s29, s9, s7
    s_and_b32 s9, s8, 0x7e
    s_lshl_b32 s9, s9, 1
    s_barrier
    s_waitcnt lgkmcnt(11)
    v_mfma_f32_32x32x16_bf16 v[32:47], v[100:103], v[96:99], v[32:47]
    ds_read_b128 v[80:83], v8 offset:49152
    ds_read_b64_tr_b16 v[84:85], v12 offset:36864
    ds_read_b64_tr_b16 v[86:87], v12 offset:37632
    s_add_u32 s29, s29, s9
    s_waitcnt lgkmcnt(12)
    v_mfma_f32_32x32x16_bf16 v[48:63], v[104:107], v[96:99], v[48:63]
    ds_read_b64_tr_b16 v[88:89], v13 offset:36864
    ds_read_b64_tr_b16 v[90:91], v13 offset:37632
    s_cmp_ge_u32 s8, 14
    s_cselect_b32 s9, 36, 0
    s_waitcnt lgkmcnt(12)
    v_mfma_f32_32x32x16_bf16 v[64:79], v[108:111], v[96:99], v[64:79]
    ds_read_b64_tr_b16 v[92:93], v14 offset:36864
    ds_read_b64_tr_b16 v[94:95], v14 offset:37632
    s_add_u32 s29, s29, s9
    s_cmp_ge_u32 s8, 28
    s_waitcnt lgkmcnt(11)
    v_mfma_f32_32x32x16_bf16 v[32:47], v[116:119], v[112:115], v[32:47]
    ds_read_b128 v[96:99], v9 offset:49152
    ds_read_b64_tr_b16 v[100:101], v12 offset:39936
    ds_read_b64_tr_b16 v[102:103], v12 offset:40704
    s_cselect_b32 s9, 36, 0
    s_waitcnt lgkmcnt(12)
    v_mfma_f32_32x32x16_bf16 v[48:63], v[120:123], v[112:115], v[48:63]
    ds_read_b64_tr_b16 v[104:105], v13 offset:39936
    ds_read_b64_tr_b16 v[106:107], v13 offset:40704
    s_add_u32 s29, s29, s9
    v_mov_b32 v24, 0xc0135761
    s_waitcnt lgkmcnt(12)
    v_mfma_f32_32x32x16_bf16 v[64:79], v[124:127], v[112:115], v[64:79]
    ds_read_b64_tr_b16 v[108:109], v14 offset:39936
    ds_read_b64_tr_b16 v[110:111], v14 offset:40704
    v_mov_b32 v25, v24
    v_mov_b32 v26, 0xbdd2d3e8
    s_waitcnt lgkmcnt(11)
    v_mfma_f32_32x32x16_bf16 v[32:47], v[84:87], v[80:83], v[32:47]
    ds_read_b128 v[112:115], v10 offset:49152
    ds_read_b64_tr_b16 v[116:117], v12 offset:43008
    ds_read_b64_tr_b16 v[118:119], v12 offset:43776
    v_mov_b32 v27, v26
    s_waitcnt lgkmcnt(12)
    v_mfma_f32_32x32x16_bf16 v[48:63], v[88:91], v[80:83], v[48:63]
    ds_read_b64_tr_b16 v[120:121], v13 offset:43008
    ds_read_b64_tr_b16 v[122:123], v13 offset:43776
    v_mov_b32 v28, 0x3f800000
    v_mov_b32 v29, v28
    s_waitcnt lgkmcnt(12)
    v_mfma_f32_32x32x16_bf16 v[64:79], v[92:95], v[80:83], v[64:79]
    ds_read_b64_tr_b16 v[124:125], v14 offset:43008
    ds_read_b64_tr_b16 v[126:127], v14 offset:43776
    s_lshl_b32 s7, s54, 2
    s_lshr_b32 s8, s55, 3
    s_waitcnt lgkmcnt(11)
    v_mfma_f32_32x32x16_bf16 v[32:47], v[100:103], v[96:99], v[32:47]
    ds_read_b128 v[80:83], v11 offset:49152
    ds_read_b64_tr_b16 v[84:85], v12 offset:46080
    ds_read_b64_tr_b16 v[86:87], v12 offset:46848
    s_lshl_b32 s8, s8, 1
    s_waitcnt lgkmcnt(12)
    v_mfma_f32_32x32x16_bf16 v[48:63], v[104:107], v[96:99], v[48:63]
    ds_read_b64_tr_b16 v[88:89], v13 offset:46080
    ds_read_b64_tr_b16 v[90:91], v13 offset:46848
    s_add_u32 s7, s7, s8
    s_and_b32 s8, s5, 1
    s_waitcnt lgkmcnt(12)
    v_mfma_f32_32x32x16_bf16 v[64:79], v[108:111], v[96:99], v[64:79]
    ds_read_b64_tr_b16 v[92:93], v14 offset:46080
    ds_read_b64_tr_b16 v[94:95], v14 offset:46848
    s_add_u32 s9, s7, s8
    s_mul_i32 s8, s9, 98304
    v_add_u32 v20, s8, v4
    s_lshl_b32 s8, s9, 15
    s_add_u32 s15, s15, s8
    s_cmp_ge_u32 s5, 2
    s_cselect_b32 s8, 0x40000000, 0
    v_add_u32 v30, s8, v20
    s_mov_b32 s14, 0
    v_mov_b32 v23, 0
    s_add_u32 s60, s59, 12288
    s_sub_u32 s7, s60, 88064
    s_cselect_b32 s60, s60, s7
    s_add_u32 s61, s60, 12288
    s_sub_u32 s7, s61, 88064
    s_cselect_b32 s61, s61, s7
    s_add_u32 s62, s61, 12288
    s_sub_u32 s7, s62, 88064
    s_waitcnt vmcnt(0)
    v_mfma_f32_32x32x16_bf16 v[32:47], v[144:147], v[160:163], v[32:47]
    v_mfma_f32_32x32x16_bf16 v[48:63], v[148:151], v[160:163], v[48:63]
    v_mfma_f32_32x32x16_bf16 v[64:79], v[152:155], v[160:163], v[64:79]
    v_mfma_f32_32x32x16_bf16 v[192:207], v[156:159], v[160:163], 0
    v_add_u32 v12, 49152, v12
    v_add_u32 v13, 49152, v13
    v_add_u32 v14, 49152, v14
    s_barrier
    s_waitcnt lgkmcnt(11)
    v_mfma_f32_32x32x16_bf16 v[32:47], v[116:119], v[112:115], v[32:47]
    ds_read_b128 v[96:99], v8 offset:0
    ds_read_b64_tr_b16 v[100:101], v12 offset:0
    ds_read_b64_tr_b16 v[102:103], v12 offset:768
    s_cselect_b32 s62, s62, s7
    s_waitcnt lgkmcnt(12)
    v_mfma_f32_32x32x16_bf16 v[48:63], v[120:123], v[112:115], v[48:63]
    ds_read_b64_tr_b16 v[104:105], v13 offset:0
    ds_read_b64_tr_b16 v[106:107], v13 offset:768
    s_add_u32 s63, s62, 12288
    s_sub_u32 s7, s63, 88064
    s_waitcnt lgkmcnt(12)
    v_mfma_f32_32x32x16_bf16 v[64:79], v[124:127], v[112:115], v[64:79]
    ds_read_b64_tr_b16 v[108:109], v14 offset:0
    ds_read_b64_tr_b16 v[110:111], v14 offset:768
    s_cselect_b32 s63, s63, s7
    s_add_u32 s64, s63, 12288
    s_waitcnt lgkmcnt(11)
    v_mfma_f32_32x32x16_bf16 v[32:47], v[84:87], v[80:83], v[32:47]
    ds_read_b128 v[112:115], v9 offset:0
    ds_read_b64_tr_b16 v[116:117], v12 offset:3072
    ds_read_b64_tr_b16 v[118:119], v12 offset:3840
    s_sub_u32 s7, s64, 88064
    s_waitcnt lgkmcnt(12)
    v_mfma_f32_32x32x16_bf16 v[48:63], v[88:91], v[80:83], v[48:63]
    ds_read_b64_tr_b16 v[120:121], v13 offset:3072
    ds_read_b64_tr_b16 v[122:123], v13 offset:3840
    s_cselect_b32 s64, s64, s7
    s_add_u32 s65, s64, 12288
    s_waitcnt lgkmcnt(12)
    v_mfma_f32_32x32x16_bf16 v[64:79], v[92:95], v[80:83], v[64:79]
    ds_read_b64_tr_b16 v[124:125], v14 offset:3072
    ds_read_b64_tr_b16 v[126:127], v14 offset:3840
    s_sub_u32 s7, s65, 88064
    s_cselect_b32 s65, s65, s7
    s_waitcnt lgkmcnt(11)
    v_mfma_f32_32x32x16_bf16 v[32:47], v[100:103], v[96:99], v[32:47]
    ds_read_b128 v[80:83], v10 offset:0
    ds_read_b64_tr_b16 v[84:85], v12 offset:6144
    ds_read_b64_tr_b16 v[86:87], v12 offset:6912
    s_add_u32 s66, s65, 12288
    s_waitcnt lgkmcnt(12)
    v_mfma_f32_32x32x16_bf16 v[48:63], v[104:107], v[96:99], v[48:63]
    ds_read_b64_tr_b16 v[88:89], v13 offset:6144
    ds_read_b64_tr_b16 v[90:91], v13 offset:6912
    s_sub_u32 s7, s66, 88064
    s_cselect_b32 s66, s66, s7
    s_waitcnt lgkmcnt(12)
    v_mfma_f32_32x32x16_bf16 v[64:79], v[108:111], v[96:99], v[64:79]
    ds_read_b64_tr_b16 v[92:93], v14 offset:6144
    ds_read_b64_tr_b16 v[94:95], v14 offset:6912
    s_add_u32 s67, s66, 12288
    s_sub_u32 s7, s67, 88064
    s_waitcnt lgkmcnt(11)
    v_mfma_f32_32x32x16_bf16 v[32:47], v[116:119], v[112:115], v[32:47]
    ds_read_b128 v[96:99], v11 offset:0
    ds_read_b64_tr_b16 v[100:101], v12 offset:9216
    ds_read_b64_tr_b16 v[102:103], v12 offset:9984
    s_cselect_b32 s67, s67, s7
    s_waitcnt lgkmcnt(12)
    v_mfma_f32_32x32x16_bf16 v[48:63], v[120:123], v[112:115], v[48:63]
    ds_read_b64_tr_b16 v[104:105], v13 offset:9216
    ds_read_b64_tr_b16 v[106:107], v13 offset:9984
    s_add_u32 s68, s67, 12288
    s_sub_u32 s7, s68, 88064
    s_waitcnt lgkmcnt(12)
    v_mfma_f32_32x32x16_bf16 v[64:79], v[124:127], v[112:115], v[64:79]
    ds_read_b64_tr_b16 v[108:109], v14 offset:9216
    ds_read_b64_tr_b16 v[110:111], v14 offset:9984
    s_cselect_b32 s68, s68, s7
    s_add_u32 s69, s68, 12288
    s_sub_u32 s7, s69, 88064
    s_cselect_b32 s69, s69, s7
    s_add_u32 s40, s69, 12288
    s_sub_u32 s7, s40, 88064
    s_cselect_b32 s40, s40, s7
    s_add_u32 s41, s40, 12288
    s_sub_u32 s7, s41, 88064
    s_cselect_b32 s41, s41, s7
    s_add_u32 s42, s41, 12288
    s_sub_u32 s7, s42, 88064
    s_cselect_b32 s42, s42, s7
    s_add_u32 s43, s42, 12288
    s_sub_u32 s7, s43, 88064
    s_cselect_b32 s43, s43, s7
    s_add_u32 s44, s43, 12288
    s_sub_u32 s7, s44, 88064
    s_barrier
    s_waitcnt lgkmcnt(11)
    v_mfma_f32_32x32x16_bf16 v[32:47], v[84:87], v[80:83], v[32:47]
    ds_read_b128 v[112:115], v8 offset:16384
    ds_read_b64_tr_b16 v[116:117], v12 offset:12288
    ds_read_b64_tr_b16 v[118:119], v12 offset:13056
    s_cselect_b32 s44, s44, s7
    s_waitcnt lgkmcnt(12)
    v_mfma_f32_32x32x16_bf16 v[48:63], v[88:91], v[80:83], v[48:63]
    ds_read_b64_tr_b16 v[120:121], v13 offset:12288
    ds_read_b64_tr_b16 v[122:123], v13 offset:13056
    s_add_u32 s45, s44, 12288
    s_sub_u32 s7, s45, 88064
    s_waitcnt lgkmcnt(12)
    v_mfma_f32_32x32x16_bf16 v[64:79], v[92:95], v[80:83], v[64:79]
    ds_read_b64_tr_b16 v[124:125], v14 offset:12288
    ds_read_b64_tr_b16 v[126:127], v14 offset:13056
    s_cselect_b32 s45, s45, s7
    s_add_u32 s46, s45, 12288
    s_waitcnt lgkmcnt(11)
    v_mfma_f32_32x32x16_bf16 v[32:47], v[100:103], v[96:99], v[32:47]
    ds_read_b128 v[80:83], v9 offset:16384
    ds_read_b64_tr_b16 v[84:85], v12 offset:15360
    ds_read_b64_tr_b16 v[86:87], v12 offset:16128
    s_sub_u32 s7, s46, 88064
    s_waitcnt lgkmcnt(12)
    v_mfma_f32_32x32x16_bf16 v[48:63], v[104:107], v[96:99], v[48:63]
    ds_read_b64_tr_b16 v[88:89], v13 offset:15360
    ds_read_b64_tr_b16 v[90:91], v13 offset:16128
    s_cselect_b32 s46, s46, s7
    s_add_u32 s47, s46, 12288
    s_waitcnt lgkmcnt(12)
    v_mfma_f32_32x32x16_bf16 v[64:79], v[108:111], v[96:99], v[64:79]
    ds_read_b64_tr_b16 v[92:93], v14 offset:15360
    ds_read_b64_tr_b16 v[94:95], v14 offset:16128
    s_sub_u32 s7, s47, 88064
    s_cselect_b32 s47, s47, s7
    s_waitcnt lgkmcnt(11)
    v_mfma_f32_32x32x16_bf16 v[32:47], v[116:119], v[112:115], v[32:47]
    ds_read_b128 v[96:99], v10 offset:16384
    ds_read_b64_tr_b16 v[100:101], v12 offset:18432
    ds_read_b64_tr_b16 v[102:103], v12 offset:19200
    s_add_u32 s48, s47, 12288
    s_waitcnt lgkmcnt(12)
    v_mfma_f32_32x32x16_bf16 v[48:63], v[120:123], v[112:115], v[48:63]
    ds_read_b64_tr_b16 v[104:105], v13 offset:18432
    ds_read_b64_tr_b16 v[106:107], v13 offset:19200
    s_sub_u32 s7, s48, 88064
    s_cselect_b32 s48, s48, s7
    s_waitcnt lgkmcnt(12)
    v_mfma_f32_32x32x16_bf16 v[64:79], v[124:127], v[112:115], v[64:79]
    ds_read_b64_tr_b16 v[108:109], v14 offset:18432
    ds_read_b64_tr_b16 v[110:111], v14 offset:19200
    s_add_u32 s49, s48, 12288
    s_sub_u32 s7, s49, 88064
    s_waitcnt lgkmcnt(11)
    v_mfma_f32_32x32x16_bf16 v[32:47], v[84:87], v[80:83], v[32:47]
    ds_read_b128 v[112:115], v11 offset:16384
    ds_read_b64_tr_b16 v[116:117], v12 offset:21504
    ds_read_b64_tr_b16 v[118:119], v12 offset:22272
    s_cselect_b32 s49, s49, s7
    s_waitcnt lgkmcnt(12)
    v_mfma_f32_32x32x16_bf16 v[48:63], v[88:91], v[80:83], v[48:63]
    ds_read_b64_tr_b16 v[120:121], v13 offset:21504
    ds_read_b64_tr_b16 v[122:123], v13 offset:22272
    s_add_u32 s50, s49, 12288
    s_sub_u32 s7, s50, 88064
    s_waitcnt lgkmcnt(12)
    v_mfma_f32_32x32x16_bf16 v[64:79], v[92:95], v[80:83], v[64:79]
    ds_read_b64_tr_b16 v[124:125], v14 offset:21504
    ds_read_b64_tr_b16 v[126:127], v14 offset:22272
    s_cselect_b32 s50, s50, s7
    s_barrier
    s_waitcnt lgkmcnt(11)
    v_mfma_f32_32x32x16_bf16 v[32:47], v[100:103], v[96:99], v[32:47]
    ds_read_b128 v[80:83], v8 offset:32768
    ds_read_b64_tr_b16 v[84:85], v12 offset:24576
    ds_read_b64_tr_b16 v[86:87], v12 offset:25344
    s_waitcnt lgkmcnt(12)
    v_mfma_f32_32x32x16_bf16 v[48:63], v[104:107], v[96:99], v[48:63]
    ds_read_b64_tr_b16 v[88:89], v13 offset:24576
    ds_read_b64_tr_b16 v[90:91], v13 offset:25344
    s_waitcnt lgkmcnt(12)
    v_mfma_f32_32x32x16_bf16 v[64:79], v[108:111], v[96:99], v[64:79]
    ds_read_b64_tr_b16 v[92:93], v14 offset:24576
    ds_read_b64_tr_b16 v[94:95], v14 offset:25344
    s_waitcnt lgkmcnt(11)
    v_mfma_f32_32x32x16_bf16 v[32:47], v[116:119], v[112:115], v[32:47]
    ds_read_b128 v[96:99], v9 offset:32768
    ds_read_b64_tr_b16 v[100:101], v12 offset:27648
    ds_read_b64_tr_b16 v[102:103], v12 offset:28416
    s_waitcnt lgkmcnt(12)
    v_mfma_f32_32x32x16_bf16 v[48:63], v[120:123], v[112:115], v[48:63]
    ds_read_b64_tr_b16 v[104:105], v13 offset:27648
    ds_read_b64_tr_b16 v[106:107], v13 offset:28416
    s_waitcnt lgkmcnt(12)
    v_mfma_f32_32x32x16_bf16 v[64:79], v[124:127], v[112:115], v[64:79]
    ds_read_b64_tr_b16 v[108:109], v14 offset:27648
    ds_read_b64_tr_b16 v[110:111], v14 offset:28416
    s_load_dword s12, s[0:1], s11
    s_waitcnt lgkmcnt(11)
    v_mfma_f32_32x32x16_bf16 v[32:47], v[84:87], v[80:83], v[32:47]
    ds_read_b128 v[112:115], v10 offset:32768
    ds_read_b64_tr_b16 v[116:117], v12 offset:30720
    ds_read_b64_tr_b16 v[118:119], v12 offset:31488
    s_waitcnt lgkmcnt(12)
    v_mfma_f32_32x32x16_bf16 v[48:63], v[88:91], v[80:83], v[48:63]
    ds_read_b64_tr_b16 v[120:121], v13 offset:30720
    ds_read_b64_tr_b16 v[122:123], v13 offset:31488
    s_waitcnt lgkmcnt(12)
    v_mfma_f32_32x32x16_bf16 v[64:79], v[92:95], v[80:83], v[64:79]
    ds_read_b64_tr_b16 v[124:125], v14 offset:30720
    ds_read_b64_tr_b16 v[126:127], v14 offset:31488
    s_waitcnt lgkmcnt(11)
    v_mfma_f32_32x32x16_bf16 v[32:47], v[100:103], v[96:99], v[32:47]
    ds_read_b128 v[80:83], v11 offset:32768
    ds_read_b64_tr_b16 v[84:85], v12 offset:33792
    ds_read_b64_tr_b16 v[86:87], v12 offset:34560
    s_waitcnt lgkmcnt(12)
    v_mfma_f32_32x32x16_bf16 v[48:63], v[104:107], v[96:99], v[48:63]
    ds_read_b64_tr_b16 v[88:89], v13 offset:33792
    ds_read_b64_tr_b16 v[90:91], v13 offset:34560
    s_waitcnt lgkmcnt(12)
    v_mfma_f32_32x32x16_bf16 v[64:79], v[108:111], v[96:99], v[64:79]
    ds_read_b64_tr_b16 v[92:93], v14 offset:33792
    ds_read_b64_tr_b16 v[94:95], v14 offset:34560
    s_waitcnt lgkmcnt(11)
    v_mfma_f32_32x32x16_bf16 v[32:47], v[116:119], v[112:115], v[32:47]
    s_waitcnt lgkmcnt(9)
    v_mfma_f32_32x32x16_bf16 v[48:63], v[120:123], v[112:115], v[48:63]
    s_waitcnt lgkmcnt(7)
    v_mfma_f32_32x32x16_bf16 v[64:79], v[124:127], v[112:115], v[64:79]
    s_waitcnt lgkmcnt(4)
    v_mfma_f32_32x32x16_bf16 v[32:47], v[84:87], v[80:83], v[32:47]
    s_waitcnt lgkmcnt(2)
    v_mfma_f32_32x32x16_bf16 v[48:63], v[88:91], v[80:83], v[48:63]
    s_waitcnt lgkmcnt(0)
    v_mfma_f32_32x32x16_bf16 v[64:79], v[92:95], v[80:83], v[64:79]
L_tag:
    s_waitcnt lgkmcnt(0)
    s_cmp_lg_u32 s12, 0
    s_cbranch_scc1 L_tagok
    s_sleep 8
    s_load_dword s12, s[0:1], s11 glc
    s_add_u32 s14, s14, 1
    s_cmp_lt_u32 s14, 500000
    s_cbranch_scc1 L_tag
    s_waitcnt lgkmcnt(0)
L_tagok:
    s_mov_b32 s13, s12
    v_mov_b32 v15, s12
    s_cmp_lt_u32 s56, s52
    s_cselect_b32 s8, 0, 0x40000000
    v_add_u32 v120, s8, v4
    s_cmp_lt_u32 s57, s52
    s_cselect_b32 s8, 0, 0x40000000
    v_add_u32 v121, s8, v4
    s_cmp_lt_u32 s58, s52
    s_cselect_b32 s8, 0, 0x40000000
    v_add_u32 v122, s8, v4
    s_barrier
    ds_read_b128 v[128:131], v8 offset:49152
    ds_read_b64_tr_b16 v[144:145], v12 offset:36864
    ds_read_b64_tr_b16 v[146:147], v12 offset:37632
    ds_read_b128 v[132:135], v9 offset:49152
    ds_read_b64_tr_b16 v[148:149], v12 offset:39936
    ds_read_b64_tr_b16 v[150:151], v12 offset:40704
    ds_read_b128 v[136:139], v10 offset:49152
    ds_read_b64_tr_b16 v[152:153], v12 offset:43008
    ds_read_b64_tr_b16 v[154:155], v12 offset:43776
    ds_read_b128 v[140:143], v11 offset:49152
    ds_read_b64_tr_b16 v[156:157], v12 offset:46080
    ds_read_b64_tr_b16 v[158:159], v12 offset:46848
    s_waitcnt lgkmcnt(9)
    v_mfma_f32_32x32x16_bf16 v[32:47], v[144:147], v[128:131], v[32:47]
    ds_read_b64_tr_b16 v[160:161], v13 offset:36864
    ds_read_b64_tr_b16 v[162:163], v13 offset:37632
    ds_read_b64_tr_b16 v[164:165], v13 offset:39936
    ds_read_b64_tr_b16 v[166:167], v13 offset:40704
    s_waitcnt lgkmcnt(10)
    v_mfma_f32_32x32x16_bf16 v[32:47], v[148:151], v[132:135], v[32:47]
    ds_read_b64_tr_b16 v[168:169], v13 offset:43008
    ds_read_b64_tr_b16 v[170:171], v13 offset:43776
    ds_read_b64_tr_b16 v[172:173], v13 offset:46080
    ds_read_b64_tr_b16 v[174:175], v13 offset:46848
    s_waitcnt lgkmcnt(11)
    v_mfma_f32_32x32x16_bf16 v[32:47], v[152:155], v[136:139], v[32:47]
    ds_read_b64_tr_b16 v[176:177], v14 offset:36864
    ds_read_b64_tr_b16 v[178:179], v14 offset:37632
    ds_read_b64_tr_b16 v[180:181], v14 offset:39936
    ds_read_b64_tr_b16 v[182:183], v14 offset:40704
    s_waitcnt lgkmcnt(12)
    v_mfma_f32_32x32x16_bf16 v[32:47], v[156:159], v[140:143], v[32:47]
    ds_read_b64_tr_b16 v[184:185], v14 offset:43008
    ds_read_b64_tr_b16 v[186:187], v14 offset:43776
    ds_read_b64_tr_b16 v[188:189], v14 offset:46080
    ds_read_b64_tr_b16 v[190:191], v14 offset:46848
    s_waitcnt lgkmcnt(14)
    v_mfma_f32_32x32x16_bf16 v[48:63], v[160:163], v[128:131], v[48:63]
    s_nop 5
    v_pk_mul_f32 v[80:81], v[32:33], v[32:33]
    v_pk_mul_f32 v[82:83], v[34:35], v[34:35]
    v_pk_fma_f32 v[80:81], v[80:81], v[26:27], v[24:25]
    v_pk_fma_f32 v[82:83], v[82:83], v[26:27], v[24:25]
    v_pk_mul_f32 v[80:81], v[80:81], v[32:33]
    v_pk_mul_f32 v[82:83], v[82:83], v[34:35]
    s_waitcnt lgkmcnt(12)
    v_mfma_f32_32x32x16_bf16 v[48:63], v[164:167], v[132:135], v[48:63]
    v_exp_f32 v80, v80
    v_exp_f32 v81, v81
    v_exp_f32 v82, v82
    v_exp_f32 v83, v83
    v_pk_add_f32 v[80:81], v[80:81], v[28:29]
    v_pk_add_f32 v[82:83], v[82:83], v[28:29]
    v_rcp_f32 v80, v80
    v_rcp_f32 v81, v81
    v_rcp_f32 v82, v82
    v_rcp_f32 v83, v83
    v_pk_mul_f32 v[80:81], v[80:81], v[32:33]
    v_pk_mul_f32 v[82:83], v[82:83], v[34:35]
    v_cvt_pk_bf16_f32 v96, v80, v81
    v_cvt_pk_bf16_f32 v97, v82, v83
    v_pk_mul_f32 v[80:81], v[36:37], v[36:37]
    v_pk_mul_f32 v[82:83], v[38:39], v[38:39]
    v_pk_fma_f32 v[80:81], v[80:81], v[26:27], v[24:25]
    v_pk_fma_f32 v[82:83], v[82:83], v[26:27], v[24:25]
    v_pk_mul_f32 v[80:81], v[80:81], v[36:37]
    v_pk_mul_f32 v[82:83], v[82:83], v[38:39]
    s_waitcnt lgkmcnt(10)
    v_mfma_f32_32x32x16_bf16 v[48:63], v[168:171], v[136:139], v[48:63]
    v_exp_f32 v80, v80
    v_exp_f32 v81, v81
    v_exp_f32 v82, v82
    v_exp_f32 v83, v83
    v_pk_add_f32 v[80:81], v[80:81], v[28:29]
    v_pk_add_f32 v[82:83], v[82:83], v[28:29]
    v_rcp_f32 v80, v80
    v_rcp_f32 v81, v81
    v_rcp_f32 v82, v82
    v_rcp_f32 v83, v83
    v_pk_mul_f32 v[80:81], v[80:81], v[36:37]
    v_pk_mul_f32 v[82:83], v[82:83], v[38:39]
    v_cvt_pk_bf16_f32 v98, v80, v81
    v_cvt_pk_bf16_f32 v99, v82, v83
    buffer_store_dwordx4 v[96:99], v120, s[32:35], s26 offen offset:0 sc1
    s_waitcnt lgkmcnt(0)
    s_barrier
    v_pk_mul_f32 v[80:81], v[40:41], v[40:41]
    v_pk_mul_f32 v[82:83], v[42:43], v[42:43]
    v_pk_fma_f32 v[80:81], v[80:81], v[26:27], v[24:25]
    v_pk_fma_f32 v[82:83], v[82:83], v[26:27], v[24:25]
    v_pk_mul_f32 v[80:81], v[80:81], v[40:41]
    v_pk_mul_f32 v[82:83], v[82:83], v[42:43]
    s_waitcnt lgkmcnt(8)
    v_mfma_f32_32x32x16_bf16 v[48:63], v[172:175], v[140:143], v[48:63]
    v_exp_f32 v80, v80
    v_exp_f32 v81, v81
    v_exp_f32 v82, v82
    v_exp_f32 v83, v83
    v_pk_add_f32 v[80:81], v[80:81], v[28:29]
    v_pk_add_f32 v[82:83], v[82:83], v[28:29]
    v_rcp_f32 v80, v80
    v_rcp_f32 v81, v81
    v_rcp_f32 v82, v82
    v_rcp_f32 v83, v83
    v_pk_mul_f32 v[80:81], v[80:81], v[40:41]
    v_pk_mul_f32 v[82:83], v[82:83], v[42:43]
    v_cvt_pk_bf16_f32 v100, v80, v81
    v_cvt_pk_bf16_f32 v101, v82, v83
    v_pk_mul_f32 v[80:81], v[44:45], v[44:45]
    v_pk_mul_f32 v[82:83], v[46:47], v[46:47]
    v_pk_fma_f32 v[80:81], v[80:81], v[26:27], v[24:25]
    v_pk_fma_f32 v[82:83], v[82:83], v[26:27], v[24:25]
    v_pk_mul_f32 v[80:81], v[80:81], v[44:45]
    v_pk_mul_f32 v[82:83], v[82:83], v[46:47]
    s_waitcnt lgkmcnt(6)
    v_mfma_f32_32x32x16_bf16 v[64:79], v[176:179], v[128:131], v[64:79]
    v_exp_f32 v80, v80
    v_exp_f32 v81, v81
    v_exp_f32 v82, v82
    v_exp_f32 v83, v83
    v_pk_add_f32 v[80:81], v[80:81], v[28:29]
    v_pk_add_f32 v[82:83], v[82:83], v[28:29]
    v_rcp_f32 v80, v80
    v_rcp_f32 v81, v81
    v_rcp_f32 v82, v82
    v_rcp_f32 v83, v83
    v_pk_mul_f32 v[80:81], v[80:81], v[44:45]
    v_pk_mul_f32 v[82:83], v[82:83], v[46:47]
    v_cvt_pk_bf16_f32 v102, v80, v81
    v_cvt_pk_bf16_f32 v103, v82, v83
    buffer_store_dwordx4 v[100:103], v120, s[32:35], s26 offen offset:1024 sc1
    v_pk_mul_f32 v[80:81], v[48:49], v[48:49]
    v_pk_mul_f32 v[82:83], v[50:51], v[50:51]
    v_pk_fma_f32 v[80:81], v[80:81], v[26:27], v[24:25]
    v_pk_fma_f32 v[82:83], v[82:83], v[26:27], v[24:25]
    v_pk_mul_f32 v[80:81], v[80:81], v[48:49]
    v_pk_mul_f32 v[82:83], v[82:83], v[50:51]
    s_waitcnt lgkmcnt(4)
    v_mfma_f32_32x32x16_bf16 v[64:79], v[180:183], v[132:135], v[64:79]
    v_exp_f32 v80, v80
    v_exp_f32 v81, v81
    v_exp_f32 v82, v82
    v_exp_f32 v83, v83
    v_pk_add_f32 v[80:81], v[80:81], v[28:29]
    v_pk_add_f32 v[82:83], v[82:83], v[28:29]
    v_rcp_f32 v80, v80
    v_rcp_f32 v81, v81
    v_rcp_f32 v82, v82
    v_rcp_f32 v83, v83
    v_pk_mul_f32 v[80:81], v[80:81], v[48:49]
    v_pk_mul_f32 v[82:83], v[82:83], v[50:51]
    v_cvt_pk_bf16_f32 v104, v80, v81
    v_cvt_pk_bf16_f32 v105, v82, v83
    v_pk_mul_f32 v[80:81], v[52:53], v[52:53]
    v_pk_mul_f32 v[82:83], v[54:55], v[54:55]
    v_pk_fma_f32 v[80:81], v[80:81], v[26:27], v[24:25]
    v_pk_fma_f32 v[82:83], v[82:83], v[26:27], v[24:25]
    v_pk_mul_f32 v[80:81], v[80:81], v[52:53]
    v_pk_mul_f32 v[82:83], v[82:83], v[54:55]
    s_waitcnt lgkmcnt(2)
    v_mfma_f32_32x32x16_bf16 v[64:79], v[184:187], v[136:139], v[64:79]
    v_exp_f32 v80, v80
    v_exp_f32 v81, v81
    v_exp_f32 v82, v82
    v_exp_f32 v83, v83
    v_pk_add_f32 v[80:81], v[80:81], v[28:29]
    v_pk_add_f32 v[82:83], v[82:83], v[28:29]
    v_rcp_f32 v80, v80
    v_rcp_f32 v81, v81
    v_rcp_f32 v82, v82
    v_rcp_f32 v83, v83
    v_pk_mul_f32 v[80:81], v[80:81], v[52:53]
    v_pk_mul_f32 v[82:83], v[82:83], v[54:55]
    v_cvt_pk_bf16_f32 v106, v80, v81
    v_cvt_pk_bf16_f32 v107, v82, v83
    buffer_store_dwordx4 v[104:107], v121, s[32:35], s27 offen offset:0 sc1
    v_pk_mul_f32 v[80:81], v[56:57], v[56:57]
    v_pk_mul_f32 v[82:83], v[58:59], v[58:59]
    v_pk_fma_f32 v[80:81], v[80:81], v[26:27], v[24:25]
    v_pk_fma_f32 v[82:83], v[82:83], v[26:27], v[24:25]
    v_pk_mul_f32 v[80:81], v[80:81], v[56:57]
    v_pk_mul_f32 v[82:83], v[82:83], v[58:59]
    s_waitcnt lgkmcnt(0)
    v_mfma_f32_32x32x16_bf16 v[64:79], v[188:191], v[140:143], v[64:79]
    v_exp_f32 v80, v80
    v_exp_f32 v81, v81
    v_exp_f32 v82, v82
    v_exp_f32 v83, v83
    v_pk_add_f32 v[80:81], v[80:81], v[28:29]
    v_pk_add_f32 v[82:83], v[82:83], v[28:29]
    v_rcp_f32 v80, v80
    v_rcp_f32 v81, v81
    v_rcp_f32 v82, v82
    v_rcp_f32 v83, v83
    v_pk_mul_f32 v[80:81], v[80:81], v[56:57]
    v_pk_mul_f32 v[82:83], v[82:83], v[58:59]
    v_cvt_pk_bf16_f32 v108, v80, v81
    v_cvt_pk_bf16_f32 v109, v82, v83
    v_pk_mul_f32 v[80:81], v[60:61], v[60:61]
    v_pk_mul_f32 v[82:83], v[62:63], v[62:63]
    v_pk_fma_f32 v[80:81], v[80:81], v[26:27], v[24:25]
    v_pk_fma_f32 v[82:83], v[82:83], v[26:27], v[24:25]
    v_pk_mul_f32 v[80:81], v[80:81], v[60:61]
    v_pk_mul_f32 v[82:83], v[82:83], v[62:63]
    v_exp_f32 v80, v80
    v_exp_f32 v81, v81
    v_exp_f32 v82, v82
    v_exp_f32 v83, v83
    v_pk_add_f32 v[80:81], v[80:81], v[28:29]
    v_pk_add_f32 v[82:83], v[82:83], v[28:29]
    v_rcp_f32 v80, v80
    v_rcp_f32 v81, v81
    v_rcp_f32 v82, v82
    v_rcp_f32 v83, v83
    v_pk_mul_f32 v[80:81], v[80:81], v[60:61]
    v_pk_mul_f32 v[82:83], v[82:83], v[62:63]
    v_cvt_pk_bf16_f32 v110, v80, v81
    v_cvt_pk_bf16_f32 v111, v82, v83
    buffer_store_dwordx4 v[108:111], v121, s[32:35], s27 offen offset:1024 sc1
    v_pk_mul_f32 v[80:81], v[64:65], v[64:65]
    v_pk_mul_f32 v[82:83], v[66:67], v[66:67]
    v_pk_fma_f32 v[80:81], v[80:81], v[26:27], v[24:25]
    v_pk_fma_f32 v[82:83], v[82:83], v[26:27], v[24:25]
    v_pk_mul_f32 v[80:81], v[80:81], v[64:65]
    v_pk_mul_f32 v[82:83], v[82:83], v[66:67]
    v_exp_f32 v80, v80
    v_exp_f32 v81, v81
    v_exp_f32 v82, v82
    v_exp_f32 v83, v83
    v_pk_add_f32 v[80:81], v[80:81], v[28:29]
    v_pk_add_f32 v[82:83], v[82:83], v[28:29]
    v_rcp_f32 v80, v80
    v_rcp_f32 v81, v81
    v_rcp_f32 v82, v82
    v_rcp_f32 v83, v83
    v_pk_mul_f32 v[80:81], v[80:81], v[64:65]
    v_pk_mul_f32 v[82:83], v[82:83], v[66:67]
    v_cvt_pk_bf16_f32 v112, v80, v81
    v_cvt_pk_bf16_f32 v113, v82, v83
    v_pk_mul_f32 v[80:81], v[68:69], v[68:69]
    v_pk_mul_f32 v[82:83], v[70:71], v[70:71]
    v_pk_fma_f32 v[80:81], v[80:81], v[26:27], v[24:25]
    v_pk_fma_f32 v[82:83], v[82:83], v[26:27], v[24:25]
    v_pk_mul_f32 v[80:81], v[80:81], v[68:69]
    v_pk_mul_f32 v[82:83], v[82:83], v[70:71]
    v_exp_f32 v80, v80
    v_exp_f32 v81, v81
    v_exp_f32 v82, v82
    v_exp_f32 v83, v83
    v_pk_add_f32 v[80:81], v[80:81], v[28:29]
    v_pk_add_f32 v[82:83], v[82:83], v[28:29]
    v_rcp_f32 v80, v80
    v_rcp_f32 v81, v81
    v_rcp_f32 v82, v82
    v_rcp_f32 v83, v83
    v_pk_mul_f32 v[80:81], v[80:81], v[68:69]
    v_pk_mul_f32 v[82:83], v[82:83], v[70:71]
    v_cvt_pk_bf16_f32 v114, v80, v81
    v_cvt_pk_bf16_f32 v115, v82, v83
    buffer_store_dwordx4 v[112:115], v122, s[32:35], s28 offen offset:0 sc1
    s_waitcnt vmcnt(3)
    s_mov_b64 exec, 1
    buffer_store_dword v15, v23, s[32:35], s24 offen sc1
    s_mov_b64 exec, -1
    v_pk_mul_f32 v[80:81], v[72:73], v[72:73]
    v_pk_mul_f32 v[82:83], v[74:75], v[74:75]
    v_pk_fma_f32 v[80:81], v[80:81], v[26:27], v[24:25]
    v_pk_fma_f32 v[82:83], v[82:83], v[26:27], v[24:25]
    v_pk_mul_f32 v[80:81], v[80:81], v[72:73]
    v_pk_mul_f32 v[82:83], v[82:83], v[74:75]
    v_exp_f32 v80, v80
    v_exp_f32 v81, v81
    v_exp_f32 v82, v82
    v_exp_f32 v83, v83
    v_pk_add_f32 v[80:81], v[80:81], v[28:29]
    v_pk_add_f32 v[82:83], v[82:83], v[28:29]
    v_rcp_f32 v80, v80
    v_rcp_f32 v81, v81
    v_rcp_f32 v82, v82
    v_rcp_f32 v83, v83
    v_pk_mul_f32 v[80:81], v[80:81], v[72:73]
    v_pk_mul_f32 v[82:83], v[82:83], v[74:75]
    v_cvt_pk_bf16_f32 v116, v80, v81
    v_cvt_pk_bf16_f32 v117, v82, v83
    v_pk_mul_f32 v[80:81], v[76:77], v[76:77]
    v_pk_mul_f32 v[82:83], v[78:79], v[78:79]
    v_pk_fma_f32 v[80:81], v[80:81], v[26:27], v[24:25]
    v_pk_fma_f32 v[82:83], v[82:83], v[26:27], v[24:25]
    v_pk_mul_f32 v[80:81], v[80:81], v[76:77]
    v_pk_mul_f32 v[82:83], v[82:83], v[78:79]
    v_exp_f32 v80, v80
    v_exp_f32 v81, v81
    v_exp_f32 v82, v82
    v_exp_f32 v83, v83
    v_pk_add_f32 v[80:81], v[80:81], v[28:29]
    v_pk_add_f32 v[82:83], v[82:83], v[28:29]
    v_rcp_f32 v80, v80
    v_rcp_f32 v81, v81
    v_rcp_f32 v82, v82
    v_rcp_f32 v83, v83
    v_pk_mul_f32 v[80:81], v[80:81], v[76:77]
    v_pk_mul_f32 v[82:83], v[82:83], v[78:79]
    v_cvt_pk_bf16_f32 v118, v80, v81
    v_cvt_pk_bf16_f32 v119, v82, v83
    buffer_store_dwordx4 v[116:119], v122, s[32:35], s28 offen offset:1024 sc1
    s_barrier
    ds_read_b64_tr_b16 v[128:129], v6 offset:0
    ds_read_b64_tr_b16 v[130:131], v6 offset:1024
    ds_read_b64_tr_b16 v[132:133], v7 offset:0
    ds_read_b64_tr_b16 v[134:135], v7 offset:1024
    ds_read_b64_tr_b16 v[136:137], v6 offset:2048
    ds_read_b64_tr_b16 v[138:139], v6 offset:3072
    ds_read_b64_tr_b16 v[140:141], v7 offset:2048
    ds_read_b64_tr_b16 v[142:143], v7 offset:3072
    ds_read_b64_tr_b16 v[144:145], v6 offset:8192
    ds_read_b64_tr_b16 v[146:147], v6 offset:9216
    ds_read_b64_tr_b16 v[148:149], v7 offset:8192
    ds_read_b64_tr_b16 v[150:151], v7 offset:9216
    ds_read_b64_tr_b16 v[152:153], v6 offset:10240
    ds_read_b64_tr_b16 v[154:155], v6 offset:11264
    ds_read_b64_tr_b16 v[156:157], v7 offset:10240
    ds_read_b64_tr_b16 v[158:159], v7 offset:11264
    v_add_u32 v24, s10, v4
    v_xor_b32 v27, 8192, v24
    s_add_u32 s8, s10, 32768
    v_and_b32 v2, 31, v1
    v_lshrrev_b32 v3, 5, v1
    v_lshlrev_b32 v12, 6, v2
    v_lshl_add_u32 v12, v3, 3, v12
    v_bfe_u32 v2, v1, 1, 2
    v_lshl_add_u32 v12, v2, 4, v12
    v_add_u32 v12, s8, v12
    v_xor_b32 v13, 16, v12
    v_xor_b32 v14, 32, v12
    v_xor_b32 v25, 48, v12
    v_bfe_u32 v2, v1, 3, 2
    v_lshlrev_b32 v2, 4, v2
    v_xor_b32 v26, v2, v4
    v_add_u32 v26, s8, v26
    s_waitcnt vmcnt(3)
    s_mov_b64 exec, 1
    buffer_store_dword v15, v23, s[32:35], s25 offen sc1
    s_mov_b64 exec, -1
    s_buffer_load_dwordx8 s[16:23], s[32:35], s30 offset:0 glc
    ds_read_b64_tr_b16 v[160:161], v6 offset:16384
    ds_read_b64_tr_b16 v[162:163], v6 offset:17408
    ds_read_b64_tr_b16 v[164:165], v7 offset:16384
    ds_read_b64_tr_b16 v[166:167], v7 offset:17408
    ds_read_b64_tr_b16 v[168:169], v6 offset:18432
    ds_read_b64_tr_b16 v[170:171], v6 offset:19456
    ds_read_b64_tr_b16 v[172:173], v7 offset:18432
    ds_read_b64_tr_b16 v[174:175], v7 offset:19456
    ds_read_b64_tr_b16 v[176:177], v6 offset:24576
    ds_read_b64_tr_b16 v[178:179], v6 offset:25600
    ds_read_b64_tr_b16 v[180:181], v7 offset:24576
    ds_read_b64_tr_b16 v[182:183], v7 offset:25600
    ds_read_b64_tr_b16 v[184:185], v6 offset:26624
    ds_read_b64_tr_b16 v[186:187], v6 offset:27648
    ds_read_b64_tr_b16 v[188:189], v7 offset:26624
    ds_read_b64_tr_b16 v[190:191], v7 offset:27648
    ds_read_b64_tr_b16 a[16:17], v6 offset:32768
    ds_read_b64_tr_b16 a[18:19], v6 offset:33792
    ds_read_b64_tr_b16 a[20:21], v7 offset:32768
    ds_read_b64_tr_b16 a[22:23], v7 offset:33792
    ds_read_b64_tr_b16 a[24:25], v6 offset:34816
    ds_read_b64_tr_b16 a[26:27], v6 offset:35840
    ds_read_b64_tr_b16 a[28:29], v7 offset:34816
    ds_read_b64_tr_b16 a[30:31], v7 offset:35840
    ds_read_b64_tr_b16 a[32:33], v6 offset:40960
    ds_read_b64_tr_b16 a[34:35], v6 offset:41984
    ds_read_b64_tr_b16 a[36:37], v7 offset:40960
    ds_read_b64_tr_b16 a[38:39], v7 offset:41984
    ds_read_b64_tr_b16 a[40:41], v6 offset:43008
    ds_read_b64_tr_b16 a[42:43], v6 offset:44032
    ds_read_b64_tr_b16 a[44:45], v7 offset:43008
    ds_read_b64_tr_b16 a[46:47], v7 offset:44032
    ds_read_b64_tr_b16 v[96:97], v6 offset:49152
    ds_read_b64_tr_b16 v[98:99], v6 offset:50176
    ds_read_b64_tr_b16 v[100:101], v7 offset:49152
    ds_read_b64_tr_b16 v[102:103], v7 offset:50176
    ds_read_b64_tr_b16 v[104:105], v6 offset:51200
    ds_read_b64_tr_b16 v[106:107], v6 offset:52224
    ds_read_b64_tr_b16 v[108:109], v7 offset:51200
    ds_read_b64_tr_b16 v[110:111], v7 offset:52224
    s_waitcnt vmcnt(1)
    s_mov_b64 exec, 1
    buffer_store_dword v15, v23, s[32:35], s29 offen sc1
    s_mov_b64 exec, -1
L_fg0:
    s_waitcnt lgkmcnt(0)
    s_mov_b32 s23, s12
    s_xor_b64 s[16:17], s[16:17], s[12:13]
    s_xor_b64 s[18:19], s[18:19], s[12:13]
    s_xor_b64 s[20:21], s[20:21], s[12:13]
    s_xor_b64 s[22:23], s[22:23], s[12:13]
    s_or_b64 s[16:17], s[16:17], s[18:19]
    s_or_b64 s[16:17], s[16:17], s[20:21]
    s_or_b64 s[16:17], s[16:17], s[22:23]
    s_cbranch_scc0 L_fgok0
    s_buffer_load_dwordx8 s[16:23], s[32:35], s30 offset:0 glc
    s_add_u32 s14, s14, 1
    s_cmp_lt_u32 s14, 500000
    s_cbranch_scc1 L_fg0
    s_waitcnt lgkmcnt(0)
L_fgok0:
    buffer_load_dwordx4 v[32:35], v20, s[32:35], s59 offen offset:0 sc1
    buffer_load_dwordx4 v[36:39], v20, s[32:35], s59 offen offset:1024 sc1
    buffer_load_dwordx4 v[40:43], v20, s[32:35], s60 offen offset:0 sc1
    buffer_load_dwordx4 v[44:47], v20, s[32:35], s60 offen offset:1024 sc1
    buffer_load_dwordx4 v[48:51], v20, s[32:35], s61 offen offset:0 sc1
    buffer_load_dwordx4 v[52:55], v20, s[32:35], s61 offen offset:1024 sc1
    buffer_load_dwordx4 v[56:59], v20, s[32:35], s62 offen offset:0 sc1
    buffer_load_dwordx4 v[60:63], v20, s[32:35], s62 offen offset:1024 sc1
    s_buffer_load_dwordx8 s[16:23], s[32:35], s30 offset:64 glc
    buffer_load_dwordx4 v[64:67], v20, s[32:35], s63 offen offset:0 sc1
    buffer_load_dwordx4 v[68:71], v20, s[32:35], s63 offen offset:1024 sc1
    buffer_load_dwordx4 v[72:75], v20, s[32:35], s64 offen offset:0 sc1
    buffer_load_dwordx4 v[76:79], v20, s[32:35], s64 offen offset:1024 sc1
    s_waitcnt vmcnt(11) lgkmcnt(15)
    v_mfma_f32_32x32x16_bf16 v[192:207], v[128:131], v[32:35], v[192:207]
    ds_read_b64_tr_b16 v[112:113], v6 offset:57344
    ds_read_b64_tr_b16 v[114:115], v6 offset:58368
    buffer_load_dwordx4 v[80:83], v20, s[32:35], s65 offen offset:0 sc1
    v_mfma_f32_32x32x16_bf16 a[0:15], v[132:135], v[32:35], 0
    ds_read_b64_tr_b16 v[116:117], v7 offset:57344
    ds_read_b64_tr_b16 v[118:119], v7 offset:58368
    s_waitcnt vmcnt(11) lgkmcnt(15)
    v_mfma_f32_32x32x16_bf16 v[192:207], v[136:139], v[36:39], v[192:207]
    ds_read_b64_tr_b16 v[120:121], v6 offset:59392
    ds_read_b64_tr_b16 v[122:123], v6 offset:60416
    buffer_load_dwordx4 v[84:87], v20, s[32:35], s65 offen offset:1024 sc1
    v_mfma_f32_32x32x16_bf16 a[0:15], v[140:143], v[36:39], a[0:15]
    ds_read_b64_tr_b16 v[124:125], v7 offset:59392
    ds_read_b64_tr_b16 v[126:127], v7 offset:60416
L_fg1:
    s_waitcnt lgkmcnt(0)
    s_mov_b32 s23, s12
    s_xor_b64 s[16:17], s[16:17], s[12:13]
    s_xor_b64 s[18:19], s[18:19], s[12:13]
    s_xor_b64 s[20:21], s[20:21], s[12:13]
    s_xor_b64 s[22:23], s[22:23], s[12:13]
    s_or_b64 s[16:17], s[16:17], s[18:19]
    s_or_b64 s[16:17], s[16:17], s[20:21]
    s_or_b64 s[16:17], s[16:17], s[22:23]
    s_cbranch_scc0 L_fgok1
    s_buffer_load_dwordx8 s[16:23], s[32:35], s30 offset:64 glc
    s_add_u32 s14, s14, 1
    s_cmp_lt_u32 s14, 500000
    s_cbranch_scc1 L_fg1
    s_waitcnt lgkmcnt(0)
L_fgok1:
    s_waitcnt vmcnt(11) lgkmcnt(15)
    v_mfma_f32_32x32x16_bf16 v[192:207], v[144:147], v[40:43], v[192:207]
    v_add_u32 v6, 0x10000, v6
    v_add_u32 v7, 0x10000, v7
    ds_read_b64_tr_b16 v[128:129], v6 offset:32768
    ds_read_b64_tr_b16 v[130:131], v6 offset:33792
    buffer_load_dwordx4 v[88:91], v20, s[32:35], s66 offen offset:0 sc1
    v_mfma_f32_32x32x16_bf16 a[0:15], v[148:151], v[40:43], a[0:15]
    ds_read_b64_tr_b16 v[132:133], v7 offset:32768
    ds_read_b64_tr_b16 v[134:135], v7 offset:33792
    s_waitcnt vmcnt(11) lgkmcnt(15)
    v_mfma_f32_32x32x16_bf16 v[192:207], v[152:155], v[44:47], v[192:207]
    ds_read_b64_tr_b16 v[136:137], v6 offset:34816
    ds_read_b64_tr_b16 v[138:139], v6 offset:35840
    buffer_load_dwordx4 v[92:95], v20, s[32:35], s66 offen offset:1024 sc1
    v_mfma_f32_32x32x16_bf16 a[0:15], v[156:159], v[44:47], a[0:15]
    ds_read_b64_tr_b16 v[140:141], v7 offset:34816
    ds_read_b64_tr_b16 v[142:143], v7 offset:35840
    s_waitcnt vmcnt(11) lgkmcnt(15)
    v_mfma_f32_32x32x16_bf16 v[192:207], v[160:163], v[48:51], v[192:207]
    ds_read_b64_tr_b16 v[144:145], v6 offset:40960
    ds_read_b64_tr_b16 v[146:147], v6 offset:41984
    buffer_load_dwordx4 v[32:35], v20, s[32:35], s67 offen offset:0 sc1
    v_mfma_f32_32x32x16_bf16 a[0:15], v[164:167], v[48:51], a[0:15]
    ds_read_b64_tr_b16 v[148:149], v7 offset:40960
    ds_read_b64_tr_b16 v[150:151], v7 offset:41984
    s_waitcnt vmcnt(11) lgkmcnt(15)
    v_mfma_f32_32x32x16_bf16 v[192:207], v[168:171], v[52:55], v[192:207]
    ds_read_b64_tr_b16 v[152:153], v6 offset:43008
    ds_read_b64_tr_b16 v[154:155], v6 offset:44032
    buffer_load_dwordx4 v[36:39], v20, s[32:35], s67 offen offset:1024 sc1
    v_mfma_f32_32x32x16_bf16 a[0:15], v[172:175], v[52:55], a[0:15]
    ds_read_b64_tr_b16 v[156:157], v7 offset:43008
    ds_read_b64_tr_b16 v[158:159], v7 offset:44032
    s_barrier
    s_waitcnt vmcnt(11) lgkmcnt(15)
    v_mfma_f32_32x32x16_bf16 v[192:207], v[176:179], v[56:59], v[192:207]
    ds_read_b64_tr_b16 v[160:161], v6 offset:49152
    ds_read_b64_tr_b16 v[162:163], v6 offset:50176
    buffer_load_dwordx4 v[40:43], v20, s[32:35], s68 offen offset:0 sc1
    v_mfma_f32_32x32x16_bf16 a[0:15], v[180:183], v[56:59], a[0:15]
    ds_read_b64_tr_b16 v[164:165], v7 offset:49152
    ds_read_b64_tr_b16 v[166:167], v7 offset:50176
    s_waitcnt vmcnt(11) lgkmcnt(15)
    v_mfma_f32_32x32x16_bf16 v[192:207], v[184:187], v[60:63], v[192:207]
    ds_read_b64_tr_b16 v[168:169], v6 offset:51200
    ds_read_b64_tr_b16 v[170:171], v6 offset:52224
    buffer_load_dwordx4 v[44:47], v20, s[32:35], s68 offen offset:1024 sc1
    v_mfma_f32_32x32x16_bf16 a[0:15], v[188:191], v[60:63], a[0:15]
    ds_read_b64_tr_b16 v[172:173], v7 offset:51200
    ds_read_b64_tr_b16 v[174:175], v7 offset:52224
    s_waitcnt vmcnt(11) lgkmcnt(15)
    v_mfma_f32_32x32x16_bf16 v[192:207], a[16:19], v[64:67], v[192:207]
    ds_read_b64_tr_b16 v[176:177], v6 offset:57344
    ds_read_b64_tr_b16 v[178:179], v6 offset:58368
    buffer_load_dwordx4 v[48:51], v20, s[32:35], s69 offen offset:0 sc1
    v_mfma_f32_32x32x16_bf16 a[0:15], a[20:23], v[64:67], a[0:15]
    ds_read_b64_tr_b16 v[180:181], v7 offset:57344
    ds_read_b64_tr_b16 v[182:183], v7 offset:58368
    s_buffer_load_dwordx8 s[16:23], s[32:35], s30 offset:128 glc
    s_waitcnt vmcnt(11) lgkmcnt(15)
    v_mfma_f32_32x32x16_bf16 v[192:207], a[24:27], v[68:71], v[192:207]
    ds_read_b64_tr_b16 v[184:185], v6 offset:59392
    ds_read_b64_tr_b16 v[186:187], v6 offset:60416
    buffer_load_dwordx4 v[52:55], v20, s[32:35], s69 offen offset:1024 sc1
    v_mfma_f32_32x32x16_bf16 a[0:15], a[28:31], v[68:71], a[0:15]
    ds_read_b64_tr_b16 v[188:189], v7 offset:59392
    ds_read_b64_tr_b16 v[190:191], v7 offset:60416
    s_waitcnt vmcnt(11) lgkmcnt(15)
    v_mfma_f32_32x32x16_bf16 v[192:207], a[32:35], v[72:75], v[192:207]
    v_add_u32 v6, 0x10000, v6
    v_add_u32 v7, 0x10000, v7
    ds_read_b64_tr_b16 a[16:17], v6 offset:0
    ds_read_b64_tr_b16 a[18:19], v6 offset:1024
    buffer_load_dwordx4 v[56:59], v20, s[32:35], s40 offen offset:0 sc1
    v_mfma_f32_32x32x16_bf16 a[0:15], a[36:39], v[72:75], a[0:15]
    ds_read_b64_tr_b16 a[20:21], v7 offset:0
    ds_read_b64_tr_b16 a[22:23], v7 offset:1024
    s_waitcnt vmcnt(11) lgkmcnt(15)
    v_mfma_f32_32x32x16_bf16 v[192:207], a[40:43], v[76:79], v[192:207]
    ds_read_b64_tr_b16 a[24:25], v6 offset:2048
    ds_read_b64_tr_b16 a[26:27], v6 offset:3072
    buffer_load_dwordx4 v[60:63], v20, s[32:35], s40 offen offset:1024 sc1
    v_mfma_f32_32x32x16_bf16 a[0:15], a[44:47], v[76:79], a[0:15]
    ds_read_b64_tr_b16 a[28:29], v7 offset:2048
    ds_read_b64_tr_b16 a[30:31], v7 offset:3072
    s_waitcnt vmcnt(11) lgkmcnt(15)
    v_mfma_f32_32x32x16_bf16 v[192:207], v[96:99], v[80:83], v[192:207]
    ds_read_b64_tr_b16 a[32:33], v6 offset:8192
    ds_read_b64_tr_b16 a[34:35], v6 offset:9216
    buffer_load_dwordx4 v[64:67], v20, s[32:35], s41 offen offset:0 sc1
    v_mfma_f32_32x32x16_bf16 a[0:15], v[100:103], v[80:83], a[0:15]
    ds_read_b64_tr_b16 a[36:37], v7 offset:8192
    ds_read_b64_tr_b16 a[38:39], v7 offset:9216
    s_waitcnt vmcnt(11) lgkmcnt(15)
    v_mfma_f32_32x32x16_bf16 v[192:207], v[104:107], v[84:87], v[192:207]
    ds_read_b64_tr_b16 a[40:41], v6 offset:10240
    ds_read_b64_tr_b16 a[42:43], v6 offset:11264
    buffer_load_dwordx4 v[68:71], v20, s[32:35], s41 offen offset:1024 sc1
    v_mfma_f32_32x32x16_bf16 a[0:15], v[108:111], v[84:87], a[0:15]
    ds_read_b64_tr_b16 a[44:45], v7 offset:10240
    ds_read_b64_tr_b16 a[46:47], v7 offset:11264
    s_barrier
    s_waitcnt vmcnt(11) lgkmcnt(15)
    v_mfma_f32_32x32x16_bf16 v[192:207], v[112:115], v[88:91], v[192:207]
    ds_read_b64_tr_b16 v[96:97], v6 offset:16384
    ds_read_b64_tr_b16 v[98:99], v6 offset:17408
    buffer_load_dwordx4 v[72:75], v20, s[32:35], s42 offen offset:0 sc1
    v_mfma_f32_32x32x16_bf16 a[0:15], v[116:119], v[88:91], a[0:15]
    ds_read_b64_tr_b16 v[100:101], v7 offset:16384
    ds_read_b64_tr_b16 v[102:103], v7 offset:17408
    s_waitcnt vmcnt(11) lgkmcnt(15)
    v_mfma_f32_32x32x16_bf16 v[192:207], v[120:123], v[92:95], v[192:207]
    ds_read_b64_tr_b16 v[104:105], v6 offset:18432
    ds_read_b64_tr_b16 v[106:107], v6 offset:19456
    buffer_load_dwordx4 v[76:79], v20, s[32:35], s42 offen offset:1024 sc1
    v_mfma_f32_32x32x16_bf16 a[0:15], v[124:127], v[92:95], a[0:15]
    ds_read_b64_tr_b16 v[108:109], v7 offset:18432
    ds_read_b64_tr_b16 v[110:111], v7 offset:19456
L_fg2:
    s_waitcnt lgkmcnt(0)
    s_cmp_ge_u32 s5, 2
    s_cselect_b32 s23, s12, s23
    s_xor_b64 s[16:17], s[16:17], s[12:13]
    s_xor_b64 s[18:19], s[18:19], s[12:13]
    s_xor_b64 s[20:21], s[20:21], s[12:13]
    s_xor_b64 s[22:23], s[22:23], s[12:13]
    s_or_b64 s[16:17], s[16:17], s[18:19]
    s_or_b64 s[16:17], s[16:17], s[20:21]
    s_or_b64 s[16:17], s[16:17], s[22:23]
    s_cbranch_scc0 L_fgok2
    s_buffer_load_dwordx8 s[16:23], s[32:35], s30 offset:128 glc
    s_add_u32 s14, s14, 1
    s_cmp_lt_u32 s14, 500000
    s_cbranch_scc1 L_fg2
    s_waitcnt lgkmcnt(0)
L_fgok2:
    s_waitcnt vmcnt(11) lgkmcnt(15)
    v_mfma_f32_32x32x16_bf16 v[192:207], v[128:131], v[32:35], v[192:207]
    ds_read_b64_tr_b16 v[112:113], v6 offset:24576
    ds_read_b64_tr_b16 v[114:115], v6 offset:25600
    buffer_load_dwordx4 v[80:83], v20, s[32:35], s43 offen offset:0 sc1
    v_mfma_f32_32x32x16_bf16 a[0:15], v[132:135], v[32:35], a[0:15]
    ds_read_b64_tr_b16 v[116:117], v7 offset:24576
    ds_read_b64_tr_b16 v[118:119], v7 offset:25600
    s_waitcnt vmcnt(11) lgkmcnt(15)
    v_mfma_f32_32x32x16_bf16 v[192:207], v[136:139], v[36:39], v[192:207]
    ds_read_b64_tr_b16 v[120:121], v6 offset:26624
    ds_read_b64_tr_b16 v[122:123], v6 offset:27648
    buffer_load_dwordx4 v[84:87], v20, s[32:35], s43 offen offset:1024 sc1
    v_mfma_f32_32x32x16_bf16 a[0:15], v[140:143], v[36:39], a[0:15]
    ds_read_b64_tr_b16 v[124:125], v7 offset:26624
    ds_read_b64_tr_b16 v[126:127], v7 offset:27648
    s_waitcnt vmcnt(11) lgkmcnt(15)
    v_mfma_f32_32x32x16_bf16 v[192:207], v[144:147], v[40:43], v[192:207]
    v_add_u32 v6, 0xffff0000, v6
    v_add_u32 v7, 0xffff0000, v7
    ds_read_b64_tr_b16 v[128:129], v6 offset:0
    ds_read_b64_tr_b16 v[130:131], v6 offset:1024
    buffer_load_dwordx4 v[88:91], v20, s[32:35], s44 offen offset:0 sc1
    v_mfma_f32_32x32x16_bf16 a[0:15], v[148:151], v[40:43], a[0:15]
    ds_read_b64_tr_b16 v[132:133], v7 offset:0
    ds_read_b64_tr_b16 v[134:135], v7 offset:1024
    s_waitcnt vmcnt(11) lgkmcnt(15)
    v_mfma_f32_32x32x16_bf16 v[192:207], v[152:155], v[44:47], v[192:207]
    ds_read_b64_tr_b16 v[136:137], v6 offset:2048
    ds_read_b64_tr_b16 v[138:139], v6 offset:3072
    buffer_load_dwordx4 v[92:95], v20, s[32:35], s44 offen offset:1024 sc1
    v_mfma_f32_32x32x16_bf16 a[0:15], v[156:159], v[44:47], a[0:15]
    ds_read_b64_tr_b16 v[140:141], v7 offset:2048
    ds_read_b64_tr_b16 v[142:143], v7 offset:3072
    s_waitcnt vmcnt(11) lgkmcnt(15)
    v_mfma_f32_32x32x16_bf16 v[192:207], v[160:163], v[48:51], v[192:207]
    ds_read_b64_tr_b16 v[144:145], v6 offset:8192
    ds_read_b64_tr_b16 v[146:147], v6 offset:9216
    buffer_load_dwordx4 v[32:35], v20, s[32:35], s45 offen offset:0 sc1
    v_mfma_f32_32x32x16_bf16 a[0:15], v[164:167], v[48:51], a[0:15]
    ds_read_b64_tr_b16 v[148:149], v7 offset:8192
    ds_read_b64_tr_b16 v[150:151], v7 offset:9216
    s_waitcnt vmcnt(11) lgkmcnt(15)
    v_mfma_f32_32x32x16_bf16 v[192:207], v[168:171], v[52:55], v[192:207]
    ds_read_b64_tr_b16 v[152:153], v6 offset:10240
    ds_read_b64_tr_b16 v[154:155], v6 offset:11264
    buffer_load_dwordx4 v[36:39], v20, s[32:35], s45 offen offset:1024 sc1
    v_mfma_f32_32x32x16_bf16 a[0:15], v[172:175], v[52:55], a[0:15]
    ds_read_b64_tr_b16 v[156:157], v7 offset:10240
    ds_read_b64_tr_b16 v[158:159], v7 offset:11264
    s_waitcnt vmcnt(11) lgkmcnt(15)
    v_mfma_f32_32x32x16_bf16 v[192:207], v[176:179], v[56:59], v[192:207]
    ds_read_b64_tr_b16 v[160:161], v6 offset:16384
    ds_read_b64_tr_b16 v[162:163], v6 offset:17408
    buffer_load_dwordx4 v[40:43], v20, s[32:35], s46 offen offset:0 sc1
    v_mfma_f32_32x32x16_bf16 a[0:15], v[180:183], v[56:59], a[0:15]
    ds_read_b64_tr_b16 v[164:165], v7 offset:16384
    ds_read_b64_tr_b16 v[166:167], v7 offset:17408
    s_waitcnt vmcnt(11) lgkmcnt(15)
    v_mfma_f32_32x32x16_bf16 v[192:207], v[184:187], v[60:63], v[192:207]
    ds_read_b64_tr_b16 v[168:169], v6 offset:18432
    ds_read_b64_tr_b16 v[170:171], v6 offset:19456
    buffer_load_dwordx4 v[44:47], v20, s[32:35], s46 offen offset:1024 sc1
    v_mfma_f32_32x32x16_bf16 a[0:15], v[188:191], v[60:63], a[0:15]
    ds_read_b64_tr_b16 v[172:173], v7 offset:18432
    ds_read_b64_tr_b16 v[174:175], v7 offset:19456
    s_waitcnt vmcnt(11) lgkmcnt(15)
    v_mfma_f32_32x32x16_bf16 v[192:207], a[16:19], v[64:67], v[192:207]
    ds_read_b64_tr_b16 v[176:177], v6 offset:24576
    ds_read_b64_tr_b16 v[178:179], v6 offset:25600
    buffer_load_dwordx4 v[48:51], v20, s[32:35], s47 offen offset:0 sc1
    v_mfma_f32_32x32x16_bf16 a[0:15], a[20:23], v[64:67], a[0:15]
    ds_read_b64_tr_b16 v[180:181], v7 offset:24576
    ds_read_b64_tr_b16 v[182:183], v7 offset:25600
    s_waitcnt vmcnt(11) lgkmcnt(15)
    v_mfma_f32_32x32x16_bf16 v[192:207], a[24:27], v[68:71], v[192:207]
    ds_read_b64_tr_b16 v[184:185], v6 offset:26624
    ds_read_b64_tr_b16 v[186:187], v6 offset:27648
    buffer_load_dwordx4 v[52:55], v20, s[32:35], s47 offen offset:1024 sc1
    v_mfma_f32_32x32x16_bf16 a[0:15], a[28:31], v[68:71], a[0:15]
    ds_read_b64_tr_b16 v[188:189], v7 offset:26624
    ds_read_b64_tr_b16 v[190:191], v7 offset:27648
    s_barrier
    s_waitcnt vmcnt(11) lgkmcnt(15)
    v_mfma_f32_32x32x16_bf16 v[192:207], a[32:35], v[72:75], v[192:207]
    v_add_u32 v6, 0xffff0000, v6
    v_add_u32 v7, 0xffff0000, v7
    ds_read_b64_tr_b16 a[16:17], v6 offset:0
    ds_read_b64_tr_b16 a[18:19], v6 offset:1024
    buffer_load_dwordx4 v[56:59], v20, s[32:35], s48 offen offset:0 sc1
    v_mfma_f32_32x32x16_bf16 a[0:15], a[36:39], v[72:75], a[0:15]
    ds_read_b64_tr_b16 a[20:21], v7 offset:0
    ds_read_b64_tr_b16 a[22:23], v7 offset:1024
    s_waitcnt vmcnt(11) lgkmcnt(15)
    v_mfma_f32_32x32x16_bf16 v[192:207], a[40:43], v[76:79], v[192:207]
    ds_read_b64_tr_b16 a[24:25], v6 offset:2048
    ds_read_b64_tr_b16 a[26:27], v6 offset:3072
    buffer_load_dwordx4 v[60:63], v20, s[32:35], s48 offen offset:1024 sc1
    v_mfma_f32_32x32x16_bf16 a[0:15], a[44:47], v[76:79], a[0:15]
    ds_read_b64_tr_b16 a[28:29], v7 offset:2048
    ds_read_b64_tr_b16 a[30:31], v7 offset:3072
    s_waitcnt vmcnt(11) lgkmcnt(15)
    v_mfma_f32_32x32x16_bf16 v[192:207], v[96:99], v[80:83], v[192:207]
    ds_read_b64_tr_b16 a[32:33], v6 offset:8192
    ds_read_b64_tr_b16 a[34:35], v6 offset:9216
    buffer_load_dwordx4 v[64:67], v20, s[32:35], s49 offen offset:0 sc1
    v_mfma_f32_32x32x16_bf16 a[0:15], v[100:103], v[80:83], a[0:15]
    ds_read_b64_tr_b16 a[36:37], v7 offset:8192
    ds_read_b64_tr_b16 a[38:39], v7 offset:9216
    s_waitcnt vmcnt(11) lgkmcnt(15)
    v_mfma_f32_32x32x16_bf16 v[192:207], v[104:107], v[84:87], v[192:207]
    ds_read_b64_tr_b16 a[40:41], v6 offset:10240
    ds_read_b64_tr_b16 a[42:43], v6 offset:11264
    buffer_load_dwordx4 v[68:71], v20, s[32:35], s49 offen offset:1024 sc1
    v_mfma_f32_32x32x16_bf16 a[0:15], v[108:111], v[84:87], a[0:15]
    ds_read_b64_tr_b16 a[44:45], v7 offset:10240
    ds_read_b64_tr_b16 a[46:47], v7 offset:11264
    s_waitcnt vmcnt(11) lgkmcnt(15)
    v_mfma_f32_32x32x16_bf16 v[192:207], v[112:115], v[88:91], v[192:207]
    buffer_load_dwordx4 v[72:75], v30, s[32:35], s50 offen offset:0 sc1
    v_mfma_f32_32x32x16_bf16 a[0:15], v[116:119], v[88:91], a[0:15]
    s_waitcnt vmcnt(11) lgkmcnt(15)
    v_mfma_f32_32x32x16_bf16 v[192:207], v[120:123], v[92:95], v[192:207]
    buffer_load_dwordx4 v[76:79], v30, s[32:35], s50 offen offset:1024 sc1
    v_mfma_f32_32x32x16_bf16 a[0:15], v[124:127], v[92:95], a[0:15]
    s_waitcnt vmcnt(11) lgkmcnt(15)
    v_mfma_f32_32x32x16_bf16 v[192:207], v[128:131], v[32:35], v[192:207]
    v_mfma_f32_32x32x16_bf16 a[0:15], v[132:135], v[32:35], a[0:15]
    s_waitcnt vmcnt(10) lgkmcnt(15)
    v_mfma_f32_32x32x16_bf16 v[192:207], v[136:139], v[36:39], v[192:207]
    v_mfma_f32_32x32x16_bf16 a[0:15], v[140:143], v[36:39], a[0:15]
    s_waitcnt vmcnt(9) lgkmcnt(15)
    v_mfma_f32_32x32x16_bf16 a[0:15], v[148:151], v[40:43], a[0:15]
    s_waitcnt vmcnt(8) lgkmcnt(15)
    v_mfma_f32_32x32x16_bf16 a[0:15], v[156:159], v[44:47], a[0:15]
    s_waitcnt vmcnt(7) lgkmcnt(15)
    v_mfma_f32_32x32x16_bf16 a[0:15], v[164:167], v[48:51], a[0:15]
    s_waitcnt vmcnt(6) lgkmcnt(15)
    v_mfma_f32_32x32x16_bf16 a[0:15], v[172:175], v[52:55], a[0:15]
    s_waitcnt vmcnt(5) lgkmcnt(15)
    v_mfma_f32_32x32x16_bf16 a[0:15], v[180:183], v[56:59], a[0:15]
    s_waitcnt vmcnt(4) lgkmcnt(15)
    v_mfma_f32_32x32x16_bf16 a[0:15], v[188:191], v[60:63], a[0:15]
    s_waitcnt vmcnt(3) lgkmcnt(12)
    v_mfma_f32_32x32x16_bf16 a[0:15], a[20:23], v[64:67], a[0:15]
    s_waitcnt vmcnt(2) lgkmcnt(8)
    v_mfma_f32_32x32x16_bf16 a[0:15], a[28:31], v[68:71], a[0:15]
    s_waitcnt vmcnt(1) lgkmcnt(4)
    v_mfma_f32_32x32x16_bf16 a[0:15], a[36:39], v[72:75], a[0:15]
    s_waitcnt vmcnt(0) lgkmcnt(0)
    v_mfma_f32_32x32x16_bf16 a[0:15], a[44:47], v[76:79], a[0:15]
    v_mfma_f32_32x32x16_bf16 v[192:207], v[144:147], v[40:43], v[192:207]
    s_nop 7
    v_mfma_f32_32x32x16_bf16 v[192:207], v[152:155], v[44:47], v[192:207]
    s_nop 1
    ds_write_b128 v24, a[0:3] offset:16384
    v_mfma_f32_32x32x16_bf16 v[192:207], v[160:163], v[48:51], v[192:207]
    ds_write_b128 v24, a[4:7] offset:17408
    v_mfma_f32_32x32x16_bf16 v[192:207], v[168:171], v[52:55], v[192:207]
    ds_write_b128 v24, a[8:11] offset:18432
    v_mfma_f32_32x32x16_bf16 v[192:207], v[176:179], v[56:59], v[192:207]
    ds_write_b128 v24, a[12:15] offset:19456
    v_mfma_f32_32x32x16_bf16 v[192:207], v[184:187], v[60:63], v[192:207]
    v_mfma_f32_32x32x16_bf16 v[192:207], a[16:19], v[64:67], v[192:207]
    s_waitcnt lgkmcnt(0)
    s_barrier
    ds_read_b128 v[80:83], v27 offset:16384
    ds_read_b128 v[84:87], v27 offset:17408
    ds_read_b128 v[88:91], v27 offset:18432
    ds_read_b128 v[92:95], v27 offset:19456
    v_mfma_f32_32x32x16_bf16 v[192:207], a[24:27], v[68:71], v[192:207]
    v_mfma_f32_32x32x16_bf16 v[192:207], a[32:35], v[72:75], v[192:207]
    v_mfma_f32_32x32x16_bf16 v[192:207], a[40:43], v[76:79], v[192:207]
    s_nop 7
    s_nop 2
    s_waitcnt lgkmcnt(3)
    v_pk_add_f32 v[80:81], v[192:193], v[80:81]
    v_pk_add_f32 v[82:83], v[194:195], v[82:83]
    v_cvt_pk_bf16_f32 v100, v80, v81
    v_cvt_pk_bf16_f32 v101, v82, v83
    ds_write_b64 v12, v[100:101]
    s_waitcnt lgkmcnt(3)
    v_pk_add_f32 v[84:85], v[196:197], v[84:85]
    v_pk_add_f32 v[86:87], v[198:199], v[86:87]
    v_cvt_pk_bf16_f32 v102, v84, v85
    v_cvt_pk_bf16_f32 v103, v86, v87
    ds_write_b64 v13, v[102:103]
    s_waitcnt lgkmcnt(3)
    v_pk_add_f32 v[88:89], v[200:201], v[88:89]
    v_pk_add_f32 v[90:91], v[202:203], v[90:91]
    v_cvt_pk_bf16_f32 v104, v88, v89
    v_cvt_pk_bf16_f32 v105, v90, v91
    ds_write_b64 v14, v[104:105]
    s_waitcnt lgkmcnt(3)
    v_pk_add_f32 v[92:93], v[204:205], v[92:93]
    v_pk_add_f32 v[94:95], v[206:207], v[94:95]
    v_cvt_pk_bf16_f32 v106, v92, v93
    v_cvt_pk_bf16_f32 v107, v94, v95
    ds_write_b64 v25, v[106:107]
    s_add_u32 s7, s15, 16384
    ds_read_b128 v[108:111], v26
    ds_read_b128 v[112:115], v26 offset:1024
    s_waitcnt lgkmcnt(1)
    buffer_store_dwordx4 v[108:111], v22, s[36:39], s15 offen sc1
    s_waitcnt lgkmcnt(0)
    buffer_store_dwordx4 v[112:115], v22, s[36:39], s7 offen sc1
L_end:
    s_endpgm
.section .rodata,"a"
.p2align 6
.amdhsa_kernel standalone__dense_activation_gelu__prompt_kernel
  .amdhsa_next_free_vgpr 256
  .amdhsa_next_free_sgpr 102
  .amdhsa_accum_offset 208
  .amdhsa_group_segment_fixed_size 0
  .amdhsa_kernarg_size 64
  .amdhsa_user_sgpr_count 2
  .amdhsa_user_sgpr_kernarg_segment_ptr 1
  .amdhsa_system_sgpr_workgroup_id_x 1
  .amdhsa_float_denorm_mode_32 3
.end_amdhsa_kernel
```
